```python
import torch

def _softmax(x, axis=-1):
    return torch.softmax(x, dim=axis)
def _gelu(x):
    return torch.nn.functional.gelu(x, approximate="tanh")
def _silu(x):
    return torch.nn.functional.silu(x)
def _sigmoid(x):
    return torch.sigmoid(x)
def _layernorm(x, axis=-1, eps=1e-5):
    m = x.mean(dim=axis, keepdim=True)
    v = x.var(dim=axis, keepdim=True, unbiased=False)
    return (x - m) / torch.sqrt(v + eps)
def _scatter_add(tgt, idx, src, axis=0):
    return tgt.clone().index_add_(axis, idx, src)
def _segment_sum(src, seg, n):
    out = torch.zeros((n,) + src.shape[1:], dtype=src.dtype)
    return out.index_add_(0, seg, src)
def _pad(x, pw):
    flat = tuple(v for pair in reversed(pw) for v in pair)
    return torch.nn.functional.pad(x, flat)

kernel_name = 'standalone__paged_block_table_kv_radixattention__decode'

def setup_inputs():

    _w = (lambda a: (lambda t: t.to(torch.bfloat16) if t.is_floating_point() else t)(torch.as_tensor(a)))
    B, H, Hkv, Dh = 4, 16, 8, 256
    Lk = 4096
    bs = 16
    nb = max(2, Lk // bs)
    P = max(1, nb // 2)
    n_phys = P + B * (nb - P)
    shared = torch.arange(P, dtype=torch.int64)
    priv = P + torch.arange(B * (nb - P), dtype=torch.int64).reshape(B, nb - P)
    bt = torch.cat([torch.tile(shared[None, :], (B, 1)), priv], dim=1)
    ctx = nb * bs - (torch.arange(1, B + 1, dtype=torch.int64) * 2654435761) % max(1, (nb * bs - P * bs) // 2)
    return {
        "q": _w((lambda *s: torch.randn(*s, dtype=torch.bfloat16) * 0.8)(B, H, Dh)),
        "k_cache": _w((lambda *s: torch.randn(*s, dtype=torch.bfloat16) * 0.8)(n_phys, bs, Hkv, Dh)),
        "v_cache": _w((lambda *s: torch.randn(*s, dtype=torch.bfloat16) * 0.05)(n_phys, bs, Hkv, Dh)),
        "block_table": _w(bt.to(torch.int64)),
        "ctx_lens": _w(torch.as_tensor(ctx).to(torch.int64)),
    }

def reference(q, k_cache, v_cache, block_table, ctx_lens):
    B, H, Dh = q.shape
    n_phys, bs, Hkv, _ = k_cache.shape
    nb = block_table.shape[1]
    Lk = nb * bs
    rep = H // Hkv
    k = k_cache[block_table].reshape(B, Lk, Hkv, Dh)
    v = v_cache[block_table].reshape(B, Lk, Hkv, Dh)
    k = (lambda x, n, axis: torch.repeat_interleave(x, n, dim=axis))(k, rep, axis=2)
    v = (lambda x, n, axis: torch.repeat_interleave(x, n, dim=axis))(v, rep, axis=2)
    scores = torch.einsum("bhd,bkhd->bhk", q, k) * (Dh ** -0.5)
    pos = torch.arange(Lk)
    valid = pos[None, :] < ctx_lens[:, None]
    scores = torch.where(valid[:, None, :], scores, -1e9)
    p = _softmax(scores, axis=-1)
    return torch.einsum("bhk,bkhd->bhd", p, v)
```

```asm
; @launch grid=(256,1,1) block=(320,1,1) lds=143360
.amdgcn_target "amdgcn-amd-amdhsa--gfx950"
.text
.globl standalone__paged_block_table_kv_radixattention__decode_kernel
.p2align 12
.fill 832, 4, 0xbf810000
.p2align 8
.type standalone__paged_block_table_kv_radixattention__decode_kernel,@function
standalone__paged_block_table_kv_radixattention__decode_kernel:
    s_load_dwordx16 s[4:19], s[0:1], 0
    s_cmp_ge_u32 s2, 256
    s_cbranch_scc1 L_end0
    v_lshrrev_b32 v30, 6, v0
    v_and_b32 v1, 63, v0
    v_readfirstlane_b32 s3, v30
    s_and_b32 s32, s2, 7
    s_lshr_b32 s33, s2, 3
    v_lshrrev_b32 v30, 5, v1
    s_sub_u32 s3, s3, 1
    s_cbranch_scc0 L_main
    s_setprio 3
    v_lshlrev_b32 v30, 1, v30
    v_xor_b32 v30, v30, v1
    s_lshl_b32 s49, s32, 10
    v_lshl_add_u32 v48, v30, 4, s49
    v_xor_b32 v49, 64, v48
    v_add_u32 v49, 7168, v49
    v_xor_b32 v50, 128, v48
    v_add_u32 v50, 14336, v50
    v_xor_b32 v51, 192, v48
    v_add_u32 v51, 21504, v51
    v_lshlrev_b32 v35, 4, v1
    v_and_b32 v31, 3, v1
    v_lshlrev_b32 v31, 2, v31
    s_lshl_b32 s50, s32, 7
    s_add_u32 s50, s50, 2130944
    s_mov_b32 m0, 131072
    s_waitcnt lgkmcnt(0)
    global_load_lds_dwordx4 v48, s[4:5] offset:0
    global_load_lds_dwordx4 v49, s[4:5] offset:1024
    global_load_lds_dwordx4 v50, s[4:5] offset:2048
    global_load_lds_dwordx4 v51, s[4:5] offset:3072
    s_mov_b32 m0, 135168
    s_load_dword s30, s[18:19], s50
    global_load_lds_dwordx4 v35, s[10:11] offset:0
    global_load_lds_dwordx4 v35, s[10:11] offset:1024
    global_load_lds_dwordx4 v35, s[10:11] offset:2048
    global_load_lds_dwordx4 v35, s[10:11] offset:3072
    s_mov_b32 m0, 139264
    s_nop 0
    global_load_lds_dword v31, s[12:13]
    s_branch L_helper
L_end0:
    s_endpgm
L_main:
    s_load_dwordx2 s[20:21], s[0:1], 8
    s_lshl_b32 s47, s33, 2
    s_add_u32 s47, s47, s3
    s_mov_b32 s50, 0x0
    s_mov_b32 s49, 4067204
    s_cmp_ge_u32 s47, 33
    s_cselect_b32 s50, 0xfd66476, s50
    s_cselect_b32 s49, 4149834, s49
    s_cmp_ge_u32 s47, 61
    s_cselect_b32 s50, 0xf932f61e, s50
    s_cselect_b32 s49, 4070794, s49
    s_cmp_ge_u32 s47, 87
    s_cselect_b32 s50, 0xfadbaed6, s50
    s_cselect_b32 s49, 4077030, s49
    s_cmp_ge_u32 s47, 106
    s_cselect_b32 s50, 0x6c7a292, s50
    s_cselect_b32 s49, 3991739, s49
    s_mul_i32 s35, s47, s49
    v_and_b32 v31, 31, v1
    s_add_u32 s35, s35, s50
    v_xor_b32 v31, v31, v30
    s_lshr_b32 s50, s35, 16
    v_lshlrev_b32 v31, 4, v31
    s_lshl_b32 s50, s50, 12
    v_lshl_or_b32 v4, v30, 12, v31
    s_lshl_b32 s45, s32, 9
    s_add_u32 s76, s50, s45
    s_add_u32 s22, s50, 131072
    s_mov_b32 s23, 0x20000
    s_lshl_b32 s39, s3, 15
    s_mov_b32 m0, s39
    v_xor_b32 v5, 32, v4
    v_add_u32 v5, 7168, v5
    v_xor_b32 v6, 64, v4
    v_add_u32 v6, 14336, v6
    v_xor_b32 v7, 96, v4
    v_add_u32 v7, 21504, v7
    s_waitcnt lgkmcnt(0)
    buffer_load_dwordx4 v4, s[20:23], s76 offen offset:0 nt lds
    buffer_load_dwordx4 v5, s[20:23], s76 offen offset:1024 nt lds
    buffer_load_dwordx4 v6, s[20:23], s76 offen offset:2048 nt lds
    buffer_load_dwordx4 v7, s[20:23], s76 offen offset:3072 nt lds
    s_bitset1_b32 m0, 12
    v_xor_b32 v8, 128, v4
    v_add_u32 v8, 32768, v8
    buffer_load_dwordx4 v8, s[20:23], s76 offen offset:0 nt lds
    v_xor_b32 v9, 160, v4
    v_add_u32 v9, 39936, v9
    buffer_load_dwordx4 v9, s[20:23], s76 offen offset:1024 nt lds
    v_xor_b32 v10, 192, v4
    v_add_u32 v10, 47104, v10
    buffer_load_dwordx4 v10, s[20:23], s76 offen offset:2048 nt lds
    v_xor_b32 v11, 224, v4
    v_add_u32 v11, 54272, v11
    buffer_load_dwordx4 v11, s[20:23], s76 offen offset:3072 nt lds
    s_add_u32 s77, s76, 65536
    s_mov_b32 s81, s22
    s_add_u32 m0, s39, 8192
    s_mov_b32 s22, s81
    buffer_load_dwordx4 v4, s[20:23], s77 offen offset:0 nt lds
    buffer_load_dwordx4 v5, s[20:23], s77 offen offset:1024 nt lds
    buffer_load_dwordx4 v6, s[20:23], s77 offen offset:2048 nt lds
    buffer_load_dwordx4 v7, s[20:23], s77 offen offset:3072 nt lds
    s_bitset1_b32 m0, 12
    s_nop 0
    buffer_load_dwordx4 v8, s[20:23], s77 offen offset:0 nt lds
    buffer_load_dwordx4 v9, s[20:23], s77 offen offset:1024 nt lds
    buffer_load_dwordx4 v10, s[20:23], s77 offen offset:2048 nt lds
    buffer_load_dwordx4 v11, s[20:23], s77 offen offset:3072 nt lds
    s_mov_b32 s48, 8192
    s_cmp_ge_u32 s47, 33
    s_cselect_b32 s48, 16923648, s48
    s_cmp_ge_u32 s47, 61
    s_cselect_b32 s48, 16799232, s48
    s_cmp_ge_u32 s47, 87
    s_cselect_b32 s48, 16869632, s48
    s_cmp_ge_u32 s47, 106
    s_cselect_b32 s48, 17006336, s48
    s_add_u32 s36, s35, s49
    s_bfe_u32 s34, s48, 0x80010
    s_lshr_b32 s37, s48, 24
    s_mov_b32 s24, s8
    s_mov_b32 s25, s9
    s_mov_b32 s27, 0x20000
    v_and_b32 v2, 15, v1
    v_lshrrev_b32 v3, 4, v1
    v_lshlrev_b32 v12, 4, v2
    v_lshl_or_b32 v12, v3, 14, v12
    v_add_u32 v13, 4096, v12
    v_add_u32 v14, 8192, v12
    v_add_u32 v15, 12288, v12
    s_lshr_b32 s35, s35, 16
    s_lshr_b32 s36, s36, 16
    s_lshl_b32 s49, s34, 11
    s_sub_u32 s35, s35, s49
    s_sub_u32 s36, s36, s49
    s_bfe_u32 s49, s48, 0x80008
    s_cmp_eq_u32 s49, s47
    s_cselect_b32 s49, s37, 0
    s_cmp_eq_u32 s49, 1
    s_cselect_b32 s36, 4096, s36
    s_cmp_eq_u32 s37, 0
    s_cselect_b32 s49, 3, 0
    s_cselect_b32 s50, 7, 63
    s_lshr_b32 s47, s35, 4
    v_and_b32 v25, s50, v1
    v_add_u32 v25, s47, v25
    v_lshrrev_b32 v30, 3, v1
    v_and_b32 v30, s49, v30
    v_or_b32 v30, s34, v30
    v_min_u32 v31, 255, v25
    v_lshlrev_b32 v245, 2, v31
    v_add_u32 v245, 131072, v245
    v_lshl_add_u32 v24, v30, 10, v245
    v_lshlrev_b32 v25, 4, v25
    v_add_u32 v34, s3, v1
    v_and_b32 v34, s49, v34
    v_or_b32 v34, s34, v34
    v_lshlrev_b32 v26, 2, v34
    v_add_u32 v26, 131072, v26
    s_mov_b32 s57, 0x6f4f2f0f
    s_cmp_ge_u32 s33, 8
    s_cselect_b32 s57, 0x624f2801, s57
    s_cmp_ge_u32 s33, 9
    s_cselect_b32 s57, 0xdf5f, s57
    s_cmp_ge_u32 s33, 15
    s_cselect_b32 s57, 0xd254971e, s57
    s_cmp_ge_u32 s33, 16
    s_cselect_b32 s57, 0x9f1f, s57
    s_cmp_ge_u32 s33, 21
    s_cselect_b32 s57, 0xb1329b17, s57
    s_cmp_ge_u32 s33, 22
    s_cselect_b32 s57, 0xbf3f, s57
    s_cmp_ge_u32 s33, 26
    s_cselect_b32 s57, 0xf973b933, s57
    s_cmp_ge_u32 s33, 27
    s_cselect_b32 s57, 0xff7f, s57
    s_lshl_b32 s49, s3, 3
    s_lshr_b32 s57, s57, s49
    s_bfe_u32 s73, s57, 0x10004
    s_bfe_u32 s72, s57, 0x20005
    s_bfe_u32 s43, s57, 0x10007
    s_lshl_b32 s43, s43, 10
    s_and_b32 s57, s57, 15
    s_lshl_b32 s49, s32, 5
    s_add_u32 s49, s49, s33
    s_lshl_b32 s49, s49, 13
    s_add_u32 s58, s18, s49
    s_addc_u32 s59, s19, 0
    s_lshl_b32 s49, s72, 11
    s_add_u32 s49, s49, s43
    v_lshl_add_u32 v35, v1, 4, s49
    v_lshl_add_u32 v247, v2, 7, s49
    s_mov_b32 s46, 0x3db8aa3b
    s_mov_b32 s42, 0
    v_mov_b32 v40, 0xff800000
    v_mov_b32 v27, 0xf149f200
    v_mov_b32 v28, 0
    v_lshlrev_b32 v30, 9, v2
    v_add_u32 v30, s39, v30
    v_xor_b32 v31, v3, v2
    v_xor_b32 v16, 0, v31
    v_lshl_add_u32 v16, v16, 4, v30
    v_xor_b32 v17, 4, v31
    v_lshl_add_u32 v17, v17, 4, v30
    v_xor_b32 v18, 8, v31
    v_lshl_add_u32 v18, v18, 4, v30
    v_xor_b32 v19, 12, v31
    v_lshl_add_u32 v19, v19, 4, v30
    v_and_b32 v30, 1, v1
    v_lshlrev_b32 v30, 4, v30
    v_mov_b32 v31, 0xffff
    v_lshlrev_b32 v30, v30, v31
    v_bfe_u32 v31, v1, 1, 2
    v_cmp_eq_u32 s[60:61], 0, v31
    v_cmp_eq_u32 s[62:63], 1, v31
    v_cmp_eq_u32 s[64:65], 2, v31
    v_cmp_eq_u32 s[66:67], 3, v31
    v_mov_b64 v[192:193], 0
    v_mov_b64 v[194:195], 0
    v_mov_b64 v[196:197], 0
    v_mov_b64 v[198:199], 0
    v_mov_b64 v[200:201], 0
    v_mov_b64 v[202:203], 0
    v_mov_b64 v[204:205], 0
    v_mov_b64 v[206:207], 0
    v_mov_b64 v[208:209], 0
    v_mov_b64 v[210:211], 0
    v_mov_b64 v[212:213], 0
    v_mov_b64 v[214:215], 0
    v_mov_b64 v[216:217], 0
    v_mov_b64 v[218:219], 0
    v_mov_b64 v[220:221], 0
    v_mov_b64 v[222:223], 0
    v_cndmask_b32 v20, 0, v30, s[60:61]
    v_cndmask_b32 v21, 0, v30, s[62:63]
    v_cndmask_b32 v22, 0, v30, s[64:65]
    v_cndmask_b32 v23, 0, v30, s[66:67]
    v_mov_b32 v30, 139840
    ds_write_b128 v30, v[192:195]
    ds_write_b128 v30, v[192:195] offset:1024
    v_lshlrev_b32 v29, 4, v1
    s_add_u32 s49, s3, 0
    s_and_b32 s49, s49, 3
    s_sub_u32 s50, s72, s49
    s_and_b32 s50, s50, 3
    s_lshl_b32 s49, s49, 4
    s_add_u32 s49, s49, s50
    s_lshl_b32 s49, s49, 11
    s_add_u32 s49, s49, s43
    s_bitcmp1_b32 s57, 0
    s_cselect_b64 vcc, -1, 0
    v_add_u32 v31, s49, v29
    v_cndmask_b32 v240, v30, v31, vcc
    s_add_u32 s49, s3, 1
    s_and_b32 s49, s49, 3
    s_sub_u32 s50, s72, s49
    s_and_b32 s50, s50, 3
    s_lshl_b32 s49, s49, 4
    s_add_u32 s49, s49, s50
    s_lshl_b32 s49, s49, 11
    s_add_u32 s49, s49, s43
    s_bitcmp1_b32 s57, 1
    s_cselect_b64 vcc, -1, 0
    v_add_u32 v31, s49, v29
    v_cndmask_b32 v241, v30, v31, vcc
    s_add_u32 s49, s3, 2
    s_and_b32 s49, s49, 3
    s_sub_u32 s50, s72, s49
    s_and_b32 s50, s50, 3
    s_lshl_b32 s49, s49, 4
    s_add_u32 s49, s49, s50
    s_lshl_b32 s49, s49, 11
    s_add_u32 s49, s49, s43
    s_bitcmp1_b32 s57, 2
    s_cselect_b64 vcc, -1, 0
    v_add_u32 v31, s49, v29
    v_cndmask_b32 v242, v30, v31, vcc
    s_add_u32 s49, s3, 3
    s_and_b32 s49, s49, 3
    s_sub_u32 s50, s72, s49
    s_and_b32 s50, s50, 3
    s_lshl_b32 s49, s49, 4
    s_add_u32 s49, s49, s50
    s_lshl_b32 s49, s49, 11
    s_add_u32 s49, s49, s43
    s_bitcmp1_b32 s57, 3
    s_cselect_b64 vcc, -1, 0
    v_add_u32 v31, s49, v29
    v_cndmask_b32 v243, v30, v31, vcc
    s_sub_u32 s49, s34, s3
    s_and_b32 s49, s49, 3
    s_mul_i32 s49, s49, s37
    s_lshl_b32 s49, s49, 11
    s_add_u32 s49, s49, s39
    v_add_u32 v45, s49, v29
    v_mov_b32 v244, 139776
    s_mov_b32 s31, 0xff
    v_lshlrev_b32 v246, 2, v3
    s_cmp_eq_u32 s73, 1
    s_cselect_b64 s[70:71], 0xff, -1
    s_and_b64 s[70:71], s[70:71], 0xffff
    s_cmp_eq_u32 s57, 0
    s_cselect_b64 s[70:71], 1, s[70:71]
    s_sub_u32 s49, 1, s37
    s_mul_i32 s49, s49, s3
    v_add_u32 v30, s49, v2
    v_and_b32 v30, 3, v30
    v_cmp_eq_u32 s[74:75], v30, v34
    v_lshrrev_b32 v31, 3, v2
    v_lshl_add_u32 v30, v30, 1, v31
    s_lshl_b32 s49, s3, 2
    s_add_u32 s49, s49, 139520
    v_lshl_add_u32 v41, v30, 4, s49
    v_lshl_add_u32 v30, v34, 1, v31
    v_lshlrev_b32 v42, 4, v30
    v_add_u32 v42, 139520, v42
    v_lshlrev_b32 v31, 1, v30
    v_xor_b32 v31, v31, v3
    v_lshlrev_b32 v30, 9, v30
    v_add_u32 v30, 131072, v30
    v_xor_b32 v52, 0, v31
    v_lshl_add_u32 v52, v52, 4, v30
    v_xor_b32 v53, 4, v31
    v_lshl_add_u32 v53, v53, 4, v30
    v_xor_b32 v54, 8, v31
    v_lshl_add_u32 v54, v54, 4, v30
    v_xor_b32 v55, 12, v31
    v_lshl_add_u32 v55, v55, 4, v30
    s_barrier
    ds_read_b32 v24, v24 offset:4096
    ds_read_b32 v245, v245 offset:4096
    ds_read_b32 v26, v26 offset:8192
    ds_read_b128 v[160:163], v52 offset:0
    ds_read_b128 v[164:167], v53 offset:0
    ds_read_b128 v[168:171], v54 offset:0
    ds_read_b128 v[172:175], v55 offset:0
    ds_read_b128 v[176:179], v52 offset:256
    ds_read_b128 v[180:183], v53 offset:256
    ds_read_b128 v[184:187], v54 offset:256
    ds_read_b128 v[188:191], v55 offset:256
    v_max_u32 v30, s35, v25
    v_add_u32 v31, 16, v25
    s_waitcnt lgkmcnt(8)
    v_cmp_gt_i32 vcc, 1, v26
    v_min_i32 v26, 4096, v26
    v_cmp_ne_u32 s[60:61], v24, v245
    s_cbranch_vccnz L_zeroctx
L_zeroctx_ret:
    v_readfirstlane_b32 s48, v26
    v_min_u32 v24, 639, v24
    v_lshlrev_b32 v24, 4, v24
    v_sub_u32 v24, v24, v25
    s_cmp_eq_u32 s37, 0
    s_cselect_b32 s48, 4096, s48
    s_min_u32 s36, s36, s48
    v_min_u32 v31, s36, v31
    s_lshl_b32 s49, s34, 11
    v_cmp_lt_u32 vcc, v30, v31
    v_cmp_ne_u32 s[62:63], s49, v24
    s_sub_i32 s41, s36, s35
    s_cmp_lt_i32 s41, 1
    s_cbranch_scc1 L_respec
    s_and_b64 s[62:63], s[62:63], vcc
    s_cbranch_scc1 L_respec
    v_lshl_add_u32 v30, v1, 4, s35
    s_add_u32 s41, s41, 15
    s_lshr_b32 s41, s41, 4
    v_add_u32 v31, 16, v30
    v_min_u32 v31, s36, v31
    v_add_u32 v24, s49, v30
    v_add_u32 v245, s49, v31
    v_lshl_or_b32 v25, v31, 16, v30
    v_cmp_lt_u32 vcc, v30, v31
    v_lshl_add_u32 v24, v24, 12, s45
    v_lshlrev_b32 v245, 12, v245
    v_cndmask_b32 v24, 0, v24, vcc
    v_cndmask_b32 v245, 0, v245, vcc
    s_mov_b32 s56, 0
    v_mov_b32 v248, v26
    v_readlane_b32 s76, v24, s42
    v_readlane_b32 s80, v245, s42
    v_readlane_b32 s28, v25, s42
    s_add_u32 s49, s42, 1
    v_readlane_b32 s77, v24, s49
    v_readlane_b32 s81, v245, s49
    v_readlane_b32 s29, v25, s49
    s_add_u32 s49, s42, 2
    v_readlane_b32 s78, v24, s49
    v_readlane_b32 s82, v245, s49
    v_readlane_b32 s30, v25, s49
    s_add_u32 s49, s42, 3
    v_readlane_b32 s79, v24, s49
    v_readlane_b32 s83, v245, s49
    v_readlane_b32 s69, v25, s49
    s_add_u32 s49, s42, 4
    s_cmp_ge_u32 s49, s41
    s_cselect_b32 s40, 1, 0
    s_waitcnt lgkmcnt(0)
L_go:
    s_waitcnt vmcnt(8)
    ds_read_b128 v[64:67], v16 offset:0
    ds_read_b128 v[68:71], v17 offset:0
    ds_read_b128 v[72:75], v18 offset:0
    ds_read_b128 v[76:79], v19 offset:0
    ds_read_b128 v[80:83], v16 offset:256
    ds_read_b128 v[84:87], v17 offset:256
    ds_read_b128 v[88:91], v18 offset:256
    ds_read_b128 v[92:95], v19 offset:256
    s_add_u32 m0, s39, 16384
    s_mov_b32 s22, s82
    buffer_load_dwordx4 v4, s[20:23], s78 offen offset:0 nt lds
    buffer_load_dwordx4 v5, s[20:23], s78 offen offset:1024 nt lds
    buffer_load_dwordx4 v6, s[20:23], s78 offen offset:2048 nt lds
    buffer_load_dwordx4 v7, s[20:23], s78 offen offset:3072 nt lds
    s_bitset1_b32 m0, 12
    s_nop 0
    buffer_load_dwordx4 v8, s[20:23], s78 offen offset:0 nt lds
    buffer_load_dwordx4 v9, s[20:23], s78 offen offset:1024 nt lds
    buffer_load_dwordx4 v10, s[20:23], s78 offen offset:2048 nt lds
    buffer_load_dwordx4 v11, s[20:23], s78 offen offset:3072 nt lds
    s_waitcnt lgkmcnt(7)
    v_mfma_f32_16x16x32_bf16 v[224:227], v[64:67], v[160:163], 0
    s_waitcnt lgkmcnt(6)
    v_mfma_f32_16x16x32_bf16 v[224:227], v[68:71], v[164:167], v[224:227]
    s_waitcnt lgkmcnt(5)
    v_mfma_f32_16x16x32_bf16 v[224:227], v[72:75], v[168:171], v[224:227]
    s_waitcnt lgkmcnt(4)
    v_mfma_f32_16x16x32_bf16 v[224:227], v[76:79], v[172:175], v[224:227]
    s_waitcnt lgkmcnt(3)
    v_mfma_f32_16x16x32_bf16 v[224:227], v[80:83], v[176:179], v[224:227]
    s_waitcnt lgkmcnt(2)
    v_mfma_f32_16x16x32_bf16 v[224:227], v[84:87], v[180:183], v[224:227]
    s_waitcnt lgkmcnt(1)
    v_mfma_f32_16x16x32_bf16 v[224:227], v[88:91], v[184:187], v[224:227]
    s_waitcnt lgkmcnt(0)
    v_mfma_f32_16x16x32_bf16 v[224:227], v[92:95], v[188:191], v[224:227]
    s_waitcnt vmcnt(8)
    ds_read_b128 v[64:67], v16 offset:8192
    ds_read_b128 v[68:71], v17 offset:8192
    ds_read_b128 v[72:75], v18 offset:8192
    ds_read_b128 v[76:79], v19 offset:8192
    ds_read_b128 v[80:83], v16 offset:8448
    ds_read_b128 v[84:87], v17 offset:8448
    ds_read_b128 v[88:91], v18 offset:8448
    ds_read_b128 v[92:95], v19 offset:8448
    s_add_u32 m0, s39, 24576
    s_mov_b32 s22, s83
    buffer_load_dwordx4 v4, s[20:23], s79 offen offset:0 nt lds
    buffer_load_dwordx4 v5, s[20:23], s79 offen offset:1024 nt lds
    buffer_load_dwordx4 v6, s[20:23], s79 offen offset:2048 nt lds
    buffer_load_dwordx4 v7, s[20:23], s79 offen offset:3072 nt lds
    s_bitset1_b32 m0, 12
    s_nop 0
    buffer_load_dwordx4 v8, s[20:23], s79 offen offset:0 nt lds
    buffer_load_dwordx4 v9, s[20:23], s79 offen offset:1024 nt lds
    buffer_load_dwordx4 v10, s[20:23], s79 offen offset:2048 nt lds
    buffer_load_dwordx4 v11, s[20:23], s79 offen offset:3072 nt lds
    s_lshr_b32 s50, s28, 16
    s_and_b32 s49, s28, 0xffff
    v_min_u32 v29, s50, v248
    v_subrev_u32 v29, s49, v29
    v_sub_u32 v29, v29, v246
    v_cmp_lt_i32 s[60:61], 0, v29
    v_cmp_lt_i32 s[62:63], 1, v29
    v_cmp_lt_i32 s[64:65], 2, v29
    v_cmp_lt_i32 s[66:67], 3, v29
    v_cndmask_b32 v224, v40, v224, s[60:61]
    v_cndmask_b32 v225, v40, v225, s[62:63]
    v_cndmask_b32 v226, v40, v226, s[64:65]
    v_cndmask_b32 v227, v40, v227, s[66:67]
    s_waitcnt lgkmcnt(7)
    v_mfma_f32_16x16x32_bf16 v[228:231], v[64:67], v[160:163], 0
    s_waitcnt lgkmcnt(6)
    v_mfma_f32_16x16x32_bf16 v[228:231], v[68:71], v[164:167], v[228:231]
    s_waitcnt lgkmcnt(5)
    v_mfma_f32_16x16x32_bf16 v[228:231], v[72:75], v[168:171], v[228:231]
    s_waitcnt lgkmcnt(4)
    v_mfma_f32_16x16x32_bf16 v[228:231], v[76:79], v[172:175], v[228:231]
    s_waitcnt lgkmcnt(3)
    v_mfma_f32_16x16x32_bf16 v[228:231], v[80:83], v[176:179], v[228:231]
    s_waitcnt lgkmcnt(2)
    v_mfma_f32_16x16x32_bf16 v[228:231], v[84:87], v[180:183], v[228:231]
    s_waitcnt lgkmcnt(1)
    v_mfma_f32_16x16x32_bf16 v[228:231], v[88:91], v[184:187], v[228:231]
    s_waitcnt lgkmcnt(0)
    v_mfma_f32_16x16x32_bf16 v[228:231], v[92:95], v[188:191], v[228:231]
    s_waitcnt vmcnt(8)
    ds_read_b128 v[64:67], v16 offset:16384
    ds_read_b128 v[68:71], v17 offset:16384
    ds_read_b128 v[72:75], v18 offset:16384
    ds_read_b128 v[76:79], v19 offset:16384
    ds_read_b128 v[80:83], v16 offset:16640
    ds_read_b128 v[84:87], v17 offset:16640
    ds_read_b128 v[88:91], v18 offset:16640
    ds_read_b128 v[92:95], v19 offset:16640
    s_mov_b32 s26, s80
    buffer_load_dwordx4 v[96:99], v12, s[24:27], s76 offen offset:0 nt
    buffer_load_dwordx4 v[100:103], v12, s[24:27], s76 offen offset:256 nt
    buffer_load_dwordx4 v[104:107], v13, s[24:27], s76 offen offset:0 nt
    buffer_load_dwordx4 v[108:111], v13, s[24:27], s76 offen offset:256 nt
    buffer_load_dwordx4 v[112:115], v14, s[24:27], s76 offen offset:0 nt
    buffer_load_dwordx4 v[116:119], v14, s[24:27], s76 offen offset:256 nt
    buffer_load_dwordx4 v[120:123], v15, s[24:27], s76 offen offset:0 nt
    buffer_load_dwordx4 v[124:127], v15, s[24:27], s76 offen offset:256 nt
    s_lshr_b32 s50, s29, 16
    s_and_b32 s49, s29, 0xffff
    v_min_u32 v29, s50, v248
    v_subrev_u32 v29, s49, v29
    v_sub_u32 v29, v29, v246
    v_cmp_lt_i32 s[60:61], 0, v29
    v_cmp_lt_i32 s[62:63], 1, v29
    v_cmp_lt_i32 s[64:65], 2, v29
    v_cmp_lt_i32 s[66:67], 3, v29
    v_cndmask_b32 v228, v40, v228, s[60:61]
    v_cndmask_b32 v229, v40, v229, s[62:63]
    v_cndmask_b32 v230, v40, v230, s[64:65]
    v_cndmask_b32 v231, v40, v231, s[66:67]
    s_waitcnt lgkmcnt(7)
    v_mfma_f32_16x16x32_bf16 v[232:235], v[64:67], v[160:163], 0
    s_waitcnt lgkmcnt(6)
    v_mfma_f32_16x16x32_bf16 v[232:235], v[68:71], v[164:167], v[232:235]
    s_waitcnt lgkmcnt(5)
    v_mfma_f32_16x16x32_bf16 v[232:235], v[72:75], v[168:171], v[232:235]
    s_waitcnt lgkmcnt(4)
    v_mfma_f32_16x16x32_bf16 v[232:235], v[76:79], v[172:175], v[232:235]
    s_waitcnt lgkmcnt(3)
    v_mfma_f32_16x16x32_bf16 v[232:235], v[80:83], v[176:179], v[232:235]
    s_waitcnt lgkmcnt(2)
    v_mfma_f32_16x16x32_bf16 v[232:235], v[84:87], v[180:183], v[232:235]
    s_waitcnt lgkmcnt(1)
    v_mfma_f32_16x16x32_bf16 v[232:235], v[88:91], v[184:187], v[232:235]
    s_waitcnt lgkmcnt(0)
    v_mfma_f32_16x16x32_bf16 v[232:235], v[92:95], v[188:191], v[232:235]
    s_cmp_ge_u32 s33, 9
    s_cselect_b32 s49, 4, 0
    s_add_u32 s49, s49, s3
    s_cmp_le_u32 s49, 0
    s_cbranch_scc1 T_sh0
    s_cmp_le_u32 s49, 1
    s_cbranch_scc1 T_sh1
    s_cmp_le_u32 s49, 2
    s_cbranch_scc1 T_sh2
    s_cmp_le_u32 s49, 3
    s_cbranch_scc1 T_sh3
    s_cmp_le_u32 s49, 4
    s_cbranch_scc1 T_pr1
L_touch_ret:
    s_waitcnt vmcnt(8)
    ds_read_b128 v[64:67], v16 offset:24576
    ds_read_b128 v[68:71], v17 offset:24576
    ds_read_b128 v[72:75], v18 offset:24576
    ds_read_b128 v[76:79], v19 offset:24576
    ds_read_b128 v[80:83], v16 offset:24832
    ds_read_b128 v[84:87], v17 offset:24832
    ds_read_b128 v[88:91], v18 offset:24832
    ds_read_b128 v[92:95], v19 offset:24832
    s_mov_b32 s26, s81
    buffer_load_dwordx4 v[128:131], v12, s[24:27], s77 offen offset:0 nt
    buffer_load_dwordx4 v[132:135], v12, s[24:27], s77 offen offset:256 nt
    buffer_load_dwordx4 v[136:139], v13, s[24:27], s77 offen offset:0 nt
    buffer_load_dwordx4 v[140:143], v13, s[24:27], s77 offen offset:256 nt
    buffer_load_dwordx4 v[144:147], v14, s[24:27], s77 offen offset:0 nt
    buffer_load_dwordx4 v[148:151], v14, s[24:27], s77 offen offset:256 nt
    buffer_load_dwordx4 v[152:155], v15, s[24:27], s77 offen offset:0 nt
    buffer_load_dwordx4 v[156:159], v15, s[24:27], s77 offen offset:256 nt
    s_lshr_b32 s50, s30, 16
    s_and_b32 s49, s30, 0xffff
    v_min_u32 v29, s50, v248
    v_subrev_u32 v29, s49, v29
    v_sub_u32 v29, v29, v246
    v_cmp_lt_i32 s[60:61], 0, v29
    v_cmp_lt_i32 s[62:63], 1, v29
    v_cmp_lt_i32 s[64:65], 2, v29
    v_cmp_lt_i32 s[66:67], 3, v29
    v_cndmask_b32 v232, v40, v232, s[60:61]
    v_cndmask_b32 v233, v40, v233, s[62:63]
    v_cndmask_b32 v234, v40, v234, s[64:65]
    v_cndmask_b32 v235, v40, v235, s[66:67]
    s_waitcnt lgkmcnt(7)
    v_mfma_f32_16x16x32_bf16 v[236:239], v[64:67], v[160:163], 0
    s_waitcnt lgkmcnt(6)
    v_mfma_f32_16x16x32_bf16 v[236:239], v[68:71], v[164:167], v[236:239]
    s_waitcnt lgkmcnt(5)
    v_mfma_f32_16x16x32_bf16 v[236:239], v[72:75], v[168:171], v[236:239]
    s_waitcnt lgkmcnt(4)
    v_mfma_f32_16x16x32_bf16 v[236:239], v[76:79], v[172:175], v[236:239]
    s_waitcnt lgkmcnt(3)
    v_mfma_f32_16x16x32_bf16 v[236:239], v[80:83], v[176:179], v[236:239]
    s_waitcnt lgkmcnt(2)
    v_mfma_f32_16x16x32_bf16 v[236:239], v[84:87], v[180:183], v[236:239]
    s_waitcnt lgkmcnt(1)
    v_mfma_f32_16x16x32_bf16 v[236:239], v[88:91], v[184:187], v[236:239]
    s_waitcnt lgkmcnt(0)
    v_mfma_f32_16x16x32_bf16 v[236:239], v[92:95], v[188:191], v[236:239]
    v_max3_f32 v30, v224, v225, v27
    v_max3_f32 v30, v226, v227, v30
    v_max3_f32 v30, v228, v229, v30
    v_max3_f32 v30, v230, v231, v30
    v_max3_f32 v30, v232, v233, v30
    v_max3_f32 v30, v234, v235, v30
    s_lshr_b32 s50, s69, 16
    s_and_b32 s49, s69, 0xffff
    v_min_u32 v29, s50, v248
    v_subrev_u32 v29, s49, v29
    v_sub_u32 v29, v29, v246
    v_cmp_lt_i32 s[60:61], 0, v29
    v_cmp_lt_i32 s[62:63], 1, v29
    v_cmp_lt_i32 s[64:65], 2, v29
    v_cmp_lt_i32 s[66:67], 3, v29
    v_cndmask_b32 v236, v40, v236, s[60:61]
    v_cndmask_b32 v237, v40, v237, s[62:63]
    v_cndmask_b32 v238, v40, v238, s[64:65]
    v_cndmask_b32 v239, v40, v239, s[66:67]
    v_max3_f32 v30, v236, v237, v30
    v_max3_f32 v30, v238, v239, v30
    v_mov_b32 v31, v30
    s_nop 1
    v_permlane32_swap_b32 v30, v31
    s_nop 0
    v_max_f32 v30, v30, v31
    v_mov_b32 v31, v30
    s_nop 1
    v_permlane16_swap_b32 v30, v31
    s_nop 0
    v_max_f32 v30, v30, v31
    s_cmp_eq_u32 s40, 0
    s_cbranch_scc1 L_nox
    v_mov_b32 v31, 0xf149f200
    v_cndmask_b32 v31, v31, v30, s[74:75]
    ds_write_b32 v41, v31
    s_waitcnt lgkmcnt(0)
    s_barrier
    ds_read_b128 v[48:51], v42
    s_waitcnt lgkmcnt(0)
    v_max3_f32 v30, v48, v49, v50
    v_max_f32 v30, v30, v51
    s_branch L_nox
.p2align 12
T_pr0:
    s_branch L_htouch_ret
L_nox:
    s_cmp_lg_u32 s42, 0
    s_cbranch_scc1 L_rescale
L_rescale_ret:
    v_mul_f32 v33, s46, v30
    v_mov_b32 v27, v30
    v_fma_f32 v224, v224, s46, -v33
    v_fma_f32 v225, v225, s46, -v33
    v_fma_f32 v226, v226, s46, -v33
    v_fma_f32 v227, v227, s46, -v33
    v_fma_f32 v228, v228, s46, -v33
    v_fma_f32 v229, v229, s46, -v33
    v_fma_f32 v230, v230, s46, -v33
    v_fma_f32 v231, v231, s46, -v33
    v_fma_f32 v232, v232, s46, -v33
    v_fma_f32 v233, v233, s46, -v33
    v_fma_f32 v234, v234, s46, -v33
    v_fma_f32 v235, v235, s46, -v33
    v_fma_f32 v236, v236, s46, -v33
    v_fma_f32 v237, v237, s46, -v33
    v_fma_f32 v238, v238, s46, -v33
    v_fma_f32 v239, v239, s46, -v33
    v_exp_f32 v224, v224
    v_exp_f32 v225, v225
    v_exp_f32 v226, v226
    v_exp_f32 v227, v227
    v_exp_f32 v228, v228
    v_exp_f32 v229, v229
    v_exp_f32 v230, v230
    v_exp_f32 v231, v231
    v_exp_f32 v232, v232
    v_exp_f32 v233, v233
    v_exp_f32 v234, v234
    v_exp_f32 v235, v235
    v_exp_f32 v236, v236
    v_exp_f32 v237, v237
    v_exp_f32 v238, v238
    v_exp_f32 v239, v239
    v_pk_add_f32 v[48:49], v[224:225], v[226:227]
    v_pk_add_f32 v[48:49], v[48:49], v[228:229]
    v_pk_add_f32 v[48:49], v[48:49], v[230:231]
    v_pk_add_f32 v[48:49], v[48:49], v[232:233]
    v_pk_add_f32 v[48:49], v[48:49], v[234:235]
    v_pk_add_f32 v[48:49], v[48:49], v[236:237]
    v_pk_add_f32 v[48:49], v[48:49], v[238:239]
    v_cvt_pk_bf16_f32 v224, v224, v224
    v_cvt_pk_bf16_f32 v225, v225, v225
    v_cvt_pk_bf16_f32 v226, v226, v226
    v_cvt_pk_bf16_f32 v227, v227, v227
    v_cvt_pk_bf16_f32 v228, v228, v228
    v_cvt_pk_bf16_f32 v229, v229, v229
    v_cvt_pk_bf16_f32 v230, v230, v230
    v_cvt_pk_bf16_f32 v231, v231, v231
    v_cvt_pk_bf16_f32 v232, v232, v232
    v_cvt_pk_bf16_f32 v233, v233, v233
    v_cvt_pk_bf16_f32 v234, v234, v234
    v_cvt_pk_bf16_f32 v235, v235, v235
    v_cvt_pk_bf16_f32 v236, v236, v236
    v_cvt_pk_bf16_f32 v237, v237, v237
    v_cvt_pk_bf16_f32 v238, v238, v238
    v_cvt_pk_bf16_f32 v239, v239, v239
    v_add_f32 v28, v28, v48
    v_add_f32 v28, v28, v49
    v_mov_b32 v30, v28
    v_mov_b32 v31, v30
    s_nop 1
    v_permlane32_swap_b32 v30, v31
    s_nop 0
    v_add_f32 v30, v30, v31
    v_mov_b32 v31, v30
    s_nop 1
    v_permlane16_swap_b32 v30, v31
    s_nop 0
    v_add_f32 v30, v30, v31
    v_cndmask_b32 v30, 0, v30, s[74:75]
    ds_write_b32 v41, v30 offset:128
    s_cmp_eq_u32 s40, 0
    s_cbranch_scc1 L_nol
    s_waitcnt lgkmcnt(0)
    s_barrier
L_nol:
    s_cmp_eq_u32 s37, 0
    s_cbranch_scc1 L_sh_v
L_pr_v:
    v_and_b32 v48, v224, v20
    v_and_b32 v49, v224, v21
    v_and_b32 v50, v224, v22
    v_and_b32 v51, v224, v23
    s_waitcnt vmcnt(14)
    s_nop 0
    v_mfma_f32_16x16x32_bf16 v[192:195], v[48:51], v[96:99], v[192:195]
    v_and_b32 v52, v225, v20
    v_and_b32 v53, v225, v21
    v_mfma_f32_16x16x32_bf16 v[196:199], v[48:51], v[100:103], v[196:199]
    v_and_b32 v54, v225, v22
    v_and_b32 v55, v225, v23
    s_mov_b32 s26, s82
    buffer_load_dwordx4 v[96:99], v12, s[24:27], s78 offen offset:0 nt
    buffer_load_dwordx4 v[100:103], v12, s[24:27], s78 offen offset:256 nt
    s_waitcnt vmcnt(14)
    v_mfma_f32_16x16x32_bf16 v[192:195], v[52:55], v[104:107], v[192:195]
    v_and_b32 v48, v226, v20
    v_and_b32 v49, v226, v21
    v_mfma_f32_16x16x32_bf16 v[196:199], v[52:55], v[108:111], v[196:199]
    v_and_b32 v50, v226, v22
    v_and_b32 v51, v226, v23
    buffer_load_dwordx4 v[104:107], v13, s[24:27], s78 offen offset:0 nt
    buffer_load_dwordx4 v[108:111], v13, s[24:27], s78 offen offset:256 nt
    s_waitcnt vmcnt(14)
    v_mfma_f32_16x16x32_bf16 v[192:195], v[48:51], v[112:115], v[192:195]
    v_and_b32 v52, v227, v20
    v_and_b32 v53, v227, v21
    v_mfma_f32_16x16x32_bf16 v[196:199], v[48:51], v[116:119], v[196:199]
    v_and_b32 v54, v227, v22
    v_and_b32 v55, v227, v23
    buffer_load_dwordx4 v[112:115], v14, s[24:27], s78 offen offset:0 nt
    buffer_load_dwordx4 v[116:119], v14, s[24:27], s78 offen offset:256 nt
    s_waitcnt vmcnt(14)
    v_mfma_f32_16x16x32_bf16 v[192:195], v[52:55], v[120:123], v[192:195]
    v_and_b32 v48, v228, v20
    v_and_b32 v49, v228, v21
    v_mfma_f32_16x16x32_bf16 v[196:199], v[52:55], v[124:127], v[196:199]
    v_and_b32 v50, v228, v22
    v_and_b32 v51, v228, v23
    buffer_load_dwordx4 v[120:123], v15, s[24:27], s78 offen offset:0 nt
    buffer_load_dwordx4 v[124:127], v15, s[24:27], s78 offen offset:256 nt
    s_waitcnt vmcnt(14)
    v_mfma_f32_16x16x32_bf16 v[192:195], v[48:51], v[128:131], v[192:195]
    v_and_b32 v52, v229, v20
    v_and_b32 v53, v229, v21
    v_mfma_f32_16x16x32_bf16 v[196:199], v[48:51], v[132:135], v[196:199]
    v_and_b32 v54, v229, v22
    v_and_b32 v55, v229, v23
    s_mov_b32 s26, s83
    buffer_load_dwordx4 v[128:131], v12, s[24:27], s79 offen offset:0 nt
    buffer_load_dwordx4 v[132:135], v12, s[24:27], s79 offen offset:256 nt
    s_waitcnt vmcnt(14)
    v_mfma_f32_16x16x32_bf16 v[192:195], v[52:55], v[136:139], v[192:195]
    v_and_b32 v48, v230, v20
    v_and_b32 v49, v230, v21
    v_mfma_f32_16x16x32_bf16 v[196:199], v[52:55], v[140:143], v[196:199]
    v_and_b32 v50, v230, v22
    v_and_b32 v51, v230, v23
    buffer_load_dwordx4 v[136:139], v13, s[24:27], s79 offen offset:0 nt
    buffer_load_dwordx4 v[140:143], v13, s[24:27], s79 offen offset:256 nt
    s_waitcnt vmcnt(14)
    v_mfma_f32_16x16x32_bf16 v[192:195], v[48:51], v[144:147], v[192:195]
    v_and_b32 v52, v231, v20
    v_and_b32 v53, v231, v21
    v_mfma_f32_16x16x32_bf16 v[196:199], v[48:51], v[148:151], v[196:199]
    v_and_b32 v54, v231, v22
    v_and_b32 v55, v231, v23
    buffer_load_dwordx4 v[144:147], v14, s[24:27], s79 offen offset:0 nt
    buffer_load_dwordx4 v[148:151], v14, s[24:27], s79 offen offset:256 nt
    s_waitcnt vmcnt(14)
    v_mfma_f32_16x16x32_bf16 v[192:195], v[52:55], v[152:155], v[192:195]
    v_and_b32 v48, v232, v20
    v_and_b32 v49, v232, v21
    v_mfma_f32_16x16x32_bf16 v[196:199], v[52:55], v[156:159], v[196:199]
    v_and_b32 v50, v232, v22
    v_and_b32 v51, v232, v23
    buffer_load_dwordx4 v[152:155], v15, s[24:27], s79 offen offset:0 nt
    buffer_load_dwordx4 v[156:159], v15, s[24:27], s79 offen offset:256 nt
    s_branch L_pr_u2
T_pr1:
    s_branch L_touch_ret
L_pr_u2:
    s_waitcnt vmcnt(14)
    v_mfma_f32_16x16x32_bf16 v[192:195], v[48:51], v[96:99], v[192:195]
    v_and_b32 v52, v233, v20
    v_and_b32 v53, v233, v21
    v_mfma_f32_16x16x32_bf16 v[196:199], v[48:51], v[100:103], v[196:199]
    v_and_b32 v54, v233, v22
    v_and_b32 v55, v233, v23
    s_nop 0
    s_waitcnt vmcnt(12)
    v_mfma_f32_16x16x32_bf16 v[192:195], v[52:55], v[104:107], v[192:195]
    v_and_b32 v48, v234, v20
    v_and_b32 v49, v234, v21
    v_mfma_f32_16x16x32_bf16 v[196:199], v[52:55], v[108:111], v[196:199]
    v_and_b32 v50, v234, v22
    v_and_b32 v51, v234, v23
    s_nop 0
    s_waitcnt vmcnt(10)
    v_mfma_f32_16x16x32_bf16 v[192:195], v[48:51], v[112:115], v[192:195]
    v_and_b32 v52, v235, v20
    v_and_b32 v53, v235, v21
    v_mfma_f32_16x16x32_bf16 v[196:199], v[48:51], v[116:119], v[196:199]
    v_and_b32 v54, v235, v22
    v_and_b32 v55, v235, v23
    s_nop 0
    s_waitcnt vmcnt(8)
    v_mfma_f32_16x16x32_bf16 v[192:195], v[52:55], v[120:123], v[192:195]
    v_and_b32 v48, v236, v20
    v_and_b32 v49, v236, v21
    v_mfma_f32_16x16x32_bf16 v[196:199], v[52:55], v[124:127], v[196:199]
    v_and_b32 v50, v236, v22
    v_and_b32 v51, v236, v23
    s_nop 0
    s_mov_b64 exec, s[70:71]
    global_load_dword v249, v247, s[58:59]
    s_mov_b64 exec, -1
    s_waitcnt vmcnt(7)
    v_mfma_f32_16x16x32_bf16 v[192:195], v[48:51], v[128:131], v[192:195]
    v_and_b32 v52, v237, v20
    v_and_b32 v53, v237, v21
    v_mfma_f32_16x16x32_bf16 v[196:199], v[48:51], v[132:135], v[196:199]
    v_and_b32 v54, v237, v22
    v_and_b32 v55, v237, v23
    s_nop 0
    s_waitcnt vmcnt(5)
    v_mfma_f32_16x16x32_bf16 v[192:195], v[52:55], v[136:139], v[192:195]
    v_and_b32 v48, v238, v20
    v_and_b32 v49, v238, v21
    v_mfma_f32_16x16x32_bf16 v[196:199], v[52:55], v[140:143], v[196:199]
    v_and_b32 v50, v238, v22
    v_and_b32 v51, v238, v23
    s_nop 0
    s_waitcnt vmcnt(3)
    v_mfma_f32_16x16x32_bf16 v[192:195], v[48:51], v[144:147], v[192:195]
    v_and_b32 v52, v239, v20
    v_and_b32 v53, v239, v21
    v_mfma_f32_16x16x32_bf16 v[196:199], v[48:51], v[148:151], v[196:199]
    v_and_b32 v54, v239, v22
    v_and_b32 v55, v239, v23
    s_nop 0
    s_waitcnt vmcnt(1)
    v_mfma_f32_16x16x32_bf16 v[192:195], v[52:55], v[152:155], v[192:195]
    v_mfma_f32_16x16x32_bf16 v[196:199], v[52:55], v[156:159], v[196:199]
    s_cmp_eq_u32 s40, 0
    s_cbranch_scc1 L_next
    s_cmp_eq_u32 s73, 0
    s_nop 3
    ds_write_b128 v45, v[192:195]
    ds_write_b128 v45, v[196:199] offset:1024
    s_waitcnt lgkmcnt(0)
    s_barrier
    s_cbranch_scc1 L_pr_old
    ds_read_b128 v[64:67], v240
    ds_read_b128 v[68:71], v241
    ds_read_b128 v[72:75], v242
    ds_read_b128 v[76:79], v243
    ds_read_b64 v[46:47], v244
    s_waitcnt lgkmcnt(3)
    v_pk_add_f32 v[64:65], v[64:65], v[68:69]
    v_pk_add_f32 v[66:67], v[66:67], v[70:71]
    s_waitcnt lgkmcnt(0)
    v_cmp_eq_u32 vcc, 0, v47
    v_pk_add_f32 v[72:73], v[72:73], v[76:77]
    v_pk_add_f32 v[74:75], v[74:75], v[78:79]
    v_pk_add_f32 v[64:65], v[64:65], v[72:73]
    v_pk_add_f32 v[66:67], v[66:67], v[74:75]
    v_bfi_b32 v64, s31, v46, v64
    v_bfi_b32 v66, s31, v46, v66
    s_cbranch_vccnz L_pr_safe
    global_store_dwordx4 v35, v[64:67], s[58:59]
    s_endpgm
L_pr_safe:
    global_store_dwordx4 v35, v[64:67], s[58:59] sc0 sc1
L_fin2:
    s_endpgm
L_pr_old:
    s_cmp_eq_u32 s57, 0
    s_cbranch_scc1 L_fin2
    ds_read_b128 v[192:195], v240
    ds_read_b128 v[196:199], v240 offset:1024
    s_branch L_reduce
L_helper:
    s_getreg_b32 s48, hwreg(HW_REG_XCC_ID, 0, 4)
    s_sub_u32 s50, s50, 1024
    v_and_b32 v30, 31, v1
    v_lshl_add_u32 v25, v30, 2, s50
    s_lshl_b32 s49, s33, 2
    s_add_u32 s49, s49, s50
    v_mov_b32 v31, s49
    s_waitcnt lgkmcnt(0)
    s_add_u32 s30, s30, 1
    s_and_b32 s34, s30, 0xfffffff
    s_lshl_b32 s48, s48, 28
    s_or_b32 s34, s34, s48
    v_mov_b32 v30, s34
    s_mov_b64 exec, 1
    global_store_dword v31, v30, s[18:19]
    s_mov_b64 exec, -1
    s_waitcnt vmcnt(1)
    s_barrier
    s_setprio 0
    s_branch T_pr0
L_htouch_ret:
    s_and_b32 s68, s30, 0xff
    s_mov_b32 s31, 0xff
    v_mov_b32 v46, s30
    v_mov_b32 v244, 139776
    s_mov_b32 s74, 255
    s_mov_b32 s75, 0
    s_cmp_ge_u32 s33, 9
    s_cselect_b32 s74, 48, s74
    s_cmp_ge_u32 s33, 15
    s_cselect_b32 s74, 51, s74
    s_cmp_ge_u32 s33, 16
    s_cselect_b32 s74, 3, s74
    s_cmp_ge_u32 s33, 21
    s_cselect_b32 s74, 15, s74
    s_cmp_ge_u32 s33, 22
    s_cselect_b32 s74, 12, s74
    s_cmp_ge_u32 s33, 26
    s_cselect_b32 s74, 204, s74
    s_cmp_ge_u32 s33, 27
    s_cselect_b32 s74, 192, s74
    v_and_b32 v30, 7, v1
    v_lshlrev_b32 v43, 4, v30
    v_add_u32 v43, 139520, v43
    s_lshl_b32 s49, s32, 8
    s_add_u32 s49, s49, s33
    s_lshl_b32 s49, s49, 4
    s_add_u32 s49, s49, 2097152
    v_lshl_add_u32 v44, v30, 9, s49
    s_mov_b32 s46, 0x3db8aa3b
    s_lshl_b32 s49, s32, 18
    s_add_u32 s84, s18, s49
    s_addc_u32 s85, s19, 0
    v_bfe_u32 v3, v1, 2, 2
    v_lshrrev_b32 v2, 4, v1
    v_and_b32 v32, 3, v1
    v_lshl_or_b32 v2, v2, 2, v32
    s_lshr_b32 s47, s33, 3
    s_lshl_b32 s48, s47, 3
    s_lshr_b32 s49, 0x11000c06, s48
    s_and_b32 s49, s49, 0xff
    s_lshr_b32 s50, 0x20101b16, s48
    s_and_b32 s50, s50, 0xff
    s_lshl_b32 s42, s47, 11
    s_bfe_u32 s43, s33, 0x10001
    s_lshl_b32 s44, s43, 10
    s_add_u32 s42, s42, s44
    s_bfe_u32 s41, s33, 0x10002
    s_lshl_b32 s44, s41, 9
    s_add_u32 s42, s42, s44
    s_and_b32 s38, s33, 1
    s_lshl_b32 s44, s38, 7
    s_add_u32 s42, s42, s44
    v_and_b32 v30, 7, v2
    v_lshrrev_b32 v31, 3, v2
    v_lshlrev_b32 v28, 4, v30
    v_lshl_add_u32 v28, v31, 8, v28
    v_add_u32 v28, s42, v28
    v_add_u32 v27, 0, v3
    v_lshl_add_u32 v64, v27, 13, v28
    v_add_u32 v27, 4, v3
    v_lshl_add_u32 v65, v27, 13, v28
    v_add_u32 v27, 8, v3
    v_add_u32 v34, s49, v27
    v_cmp_gt_u32 vcc, 9, v27
    s_nop 1
    v_cndmask_b32 v27, v34, v27, vcc
    v_cmp_gt_u32 s[80:81], s50, v27
    v_mov_b32 v168, s68
    v_mov_b32 v169, 0
    v_mov_b32 v170, s68
    v_mov_b32 v171, 0
    v_mov_b32 v200, s68
    v_mov_b32 v201, 0
    v_mov_b32 v202, s68
    v_mov_b32 v203, 0
    v_lshl_add_u32 v66, v27, 13, v28
    v_add_u32 v27, 12, v3
    v_add_u32 v34, s49, v27
    v_cmp_gt_u32 vcc, 9, v27
    s_nop 1
    v_cndmask_b32 v27, v34, v27, vcc
    v_cmp_gt_u32 s[82:83], s50, v27
    v_mov_b32 v172, s68
    v_mov_b32 v173, 0
    v_mov_b32 v174, s68
    v_mov_b32 v175, 0
    v_mov_b32 v204, s68
    v_mov_b32 v205, 0
    v_mov_b32 v206, s68
    v_mov_b32 v207, 0
    v_lshl_add_u32 v67, v27, 13, v28
    v_lshl_add_u32 v27, v32, 2, v3
    v_add_u32 v34, s49, v27
    v_cmp_gt_u32 vcc, 9, v27
    s_nop 1
    v_cndmask_b32 v27, v34, v27, vcc
    v_cmp_gt_u32 s[52:53], s50, v27
    s_lshl_b32 s44, s32, 3
    s_lshr_b32 s42, s33, 2
    s_add_u32 s44, s44, s42
    s_lshl_b32 s44, s44, 9
    s_add_u32 s44, s44, 2097152
    v_lshl_add_u32 v68, v27, 4, s44
    v_readfirstlane_b32 s44, v28
    s_nop 1
    v_lshl_add_u32 v69, v27, 13, s44
    v_mov_b32 v176, 0xf149f200
    v_mov_b32 v177, 0
    v_mov_b32 v178, 0
    s_lshl_b32 s42, s47, 13
    s_lshl_b32 s44, s32, 10
    s_add_u32 s42, s42, s44
    s_lshl_b32 s44, s41, 9
    s_add_u32 s42, s42, s44
    s_and_b32 s44, s33, 3
    s_lshl_b32 s44, s44, 7
    s_add_u32 s42, s42, s44
    v_lshlrev_b32 v30, 4, v30
    v_lshl_add_u32 v30, v31, 3, v30
    v_add_u32 v29, s42, v30
    s_mov_b32 s35, 4000000
    v_mov_b32 v249, 0
    s_mov_b32 s49, 4
    v_mov_b32 v47, 1
    s_mov_b64 exec, s[52:53]
    global_load_dwordx4 v[176:179], v68, s[18:19] sc1
    s_mov_b64 exec, 1
    global_load_dword v34, v64, s[84:85] sc1 nt
    s_mov_b64 exec, -1
    s_waitcnt vmcnt(0)
    global_load_dword v31, v25, s[18:19] sc1
    s_barrier
    s_barrier
    ds_read_b128 v[48:51], v43
    ds_read_b128 v[52:55], v43 offset:128
    s_waitcnt lgkmcnt(0)
    v_max3_f32 v36, v48, v49, v50
    v_pk_add_f32 v[52:53], v[52:53], v[54:55]
    v_max_f32 v36, v36, v51
    v_add_f32 v37, v52, v53
    v_lshlrev_b32 v38, 8, v36
    v_mov_b32 v39, v46
    v_bfi_b32 v36, s31, v46, v36
    v_bfi_b32 v37, s31, v46, v37
    v_bfi_b32 v38, s31, v46, v38
    s_branch L_hello1
L_hello:
    global_load_dword v31, v25, s[18:19] sc1
L_hello1:
    s_waitcnt vmcnt(0)
    v_cmp_ne_u32 vcc, s34, v31
    s_sub_u32 s49, s49, 1
    s_cbranch_vccz L_hello_ok
    s_cbranch_scc0 L_hello
    v_mov_b32 v47, 0
    s_mov_b32 s37, 0
    s_mov_b64 exec, s[74:75]
    global_store_dwordx4 v44, v[36:39], s[18:19] sc0 sc1
    s_branch L_hello_done
L_hello_ok:
    s_mov_b32 s37, 1
    s_mov_b64 exec, s[74:75]
    global_store_dwordx4 v44, v[36:39], s[18:19]
    s_cmp_lg_u32 s33, 0
    s_cbranch_scc1 L_hello_done
    s_mov_b64 exec, 1
    global_store_dword v25, v46, s[18:19] offset:1024
L_hello_done:
    s_mov_b64 exec, s[52:53]
    ds_write_b64 v244, v[46:47]
    s_waitcnt vmcnt(0)
    global_load_dwordx4 v[176:179], v68, s[18:19] sc1
    s_setprio 3
    s_waitcnt lgkmcnt(0)
    s_barrier
    s_branch L_poll1
L_poll:
    global_load_dwordx4 v[176:179], v68, s[18:19] sc1
    s_sub_u32 s35, s35, 1
    s_cbranch_scc1 L_fin
L_poll1:
    s_waitcnt vmcnt(0)
    v_bitop3_b32 v48, v176, v177, s30 bitop3:0x7e
    v_xor_b32 v49, s30, v179
    v_bitop3_b32 v48, v48, v178, s30 bitop3:0xf6
    v_and_or_b32 v48, v48, s31, v49
    v_cmp_ne_u32 vcc, 0, v48
    s_cbranch_vccnz L_poll
    s_and_b32 exec_lo, s52, 0xffff
    s_mov_b32 exec_hi, 0
L_gate:
    global_load_dword v48, v69, s[84:85] sc1
    s_sub_u32 s35, s35, 1
    s_cbranch_scc1 L_fin
    s_waitcnt vmcnt(0)
    v_and_b32 v48, 0xff, v48
    v_cmp_ne_u32 vcc, s68, v48
    s_nop 1
    s_bcnt1_i32_b32 s49, vcc_lo
    s_cmp_gt_u32 s49, 6
    s_cbranch_scc1 L_gate
    s_mov_b64 exec, -1
    global_load_dwordx4 v[160:163], v64, s[84:85] sc1
    global_load_dwordx4 v[164:167], v65, s[84:85] sc1
    s_mov_b64 exec, s[80:81]
    global_load_dwordx4 v[168:171], v66, s[84:85] sc1
    s_mov_b64 exec, s[82:83]
    global_load_dwordx4 v[172:175], v67, s[84:85] sc1
    s_mov_b64 exec, -1
    v_lshrrev_b32 v27, 8, v178
    v_bfi_b32 v27, s31, v27, v176
    v_and_b32 v28, 0xffffff00, v177
    s_nop 0
    v_max_f32_dpp v30, v27, v27 quad_perm:[1,0,3,2] row_mask:0xf bank_mask:0xf
    s_nop 1
    v_max_f32_dpp v30, v30, v30 quad_perm:[2,3,0,1] row_mask:0xf bank_mask:0xf
    s_nop 1
    v_max_f32_dpp v30, v30, v30 row_ror:4 row_mask:0xf bank_mask:0xf
    s_nop 1
    v_max_f32_dpp v30, v30, v30 row_ror:8 row_mask:0xf bank_mask:0xf
    v_sub_f32 v27, v27, v30
    v_mul_f32 v27, s46, v27
    v_exp_f32 v27, v27
    s_nop 0
    v_mul_f32 v28, v28, v27
    s_nop 1
    v_add_f32_dpp v28, v28, v28 quad_perm:[1,0,3,2] row_mask:0xf bank_mask:0xf
    s_nop 1
    v_add_f32_dpp v28, v28, v28 quad_perm:[2,3,0,1] row_mask:0xf bank_mask:0xf
    s_nop 1
    v_add_f32_dpp v28, v28, v28 row_ror:4 row_mask:0xf bank_mask:0xf
    s_nop 1
    v_add_f32_dpp v28, v28, v28 row_ror:8 row_mask:0xf bank_mask:0xf
    v_rcp_f32 v28, v28
    s_nop 0
    v_mul_f32 v27, v27, v28
    s_nop 1
    v_mov_b32_dpp v56, v27 quad_perm:[0,0,0,0] row_mask:0xf bank_mask:0xf
    v_mov_b32_dpp v58, v27 quad_perm:[1,1,1,1] row_mask:0xf bank_mask:0xf
    v_mov_b32_dpp v60, v27 quad_perm:[2,2,2,2] row_mask:0xf bank_mask:0xf
    v_mov_b32_dpp v62, v27 quad_perm:[3,3,3,3] row_mask:0xf bank_mask:0xf
    s_mov_b64 exec, -1
    global_load_dwordx4 v[192:195], v64, s[84:85] sc1
    global_load_dwordx4 v[196:199], v65, s[84:85] sc1
    s_mov_b64 exec, s[80:81]
    global_load_dwordx4 v[200:203], v66, s[84:85] sc1
    s_mov_b64 exec, s[82:83]
    global_load_dwordx4 v[204:207], v67, s[84:85] sc1
    s_mov_b64 exec, -1
L_data:
    s_waitcnt vmcnt(4)
    v_bitop3_b32 v96, v160, v162, s30 bitop3:0x7e
    v_bitop3_b32 v97, v164, v166, s30 bitop3:0x7e
    v_bitop3_b32 v98, v168, v170, s30 bitop3:0x7e
    v_bitop3_b32 v99, v172, v174, s30 bitop3:0x7e
    v_or3_b32 v96, v96, v97, v98
    v_bitop3_b32 v96, v96, v99, s31 bitop3:0xa8
    v_cmp_ne_u32 vcc, 0, v96
    s_cbranch_vccz L_final0
    s_mov_b64 exec, -1
    global_load_dwordx4 v[160:163], v64, s[84:85] sc1
    global_load_dwordx4 v[164:167], v65, s[84:85] sc1
    s_mov_b64 exec, s[80:81]
    global_load_dwordx4 v[168:171], v66, s[84:85] sc1
    s_mov_b64 exec, s[82:83]
    global_load_dwordx4 v[172:175], v67, s[84:85] sc1
    s_mov_b64 exec, -1
    s_waitcnt vmcnt(4)
    v_bitop3_b32 v96, v192, v194, s30 bitop3:0x7e
    v_bitop3_b32 v97, v196, v198, s30 bitop3:0x7e
    v_bitop3_b32 v98, v200, v202, s30 bitop3:0x7e
    v_bitop3_b32 v99, v204, v206, s30 bitop3:0x7e
    v_or3_b32 v96, v96, v97, v98
    v_bitop3_b32 v96, v96, v99, s31 bitop3:0xa8
    v_cmp_ne_u32 vcc, 0, v96
    s_cbranch_vccz L_final1
    s_mov_b64 exec, -1
    global_load_dwordx4 v[192:195], v64, s[84:85] sc1
    global_load_dwordx4 v[196:199], v65, s[84:85] sc1
    s_mov_b64 exec, s[80:81]
    global_load_dwordx4 v[200:203], v66, s[84:85] sc1
    s_mov_b64 exec, s[82:83]
    global_load_dwordx4 v[204:207], v67, s[84:85] sc1
    s_mov_b64 exec, -1
    s_sub_u32 s35, s35, 1
    s_cbranch_scc0 L_data
    s_branch L_fin
L_final0:
    v_xor_b32 v160, s68, v160
    v_xor_b32 v162, s68, v162
    v_pk_mul_f32 v[48:49], v[160:161], v[56:57] op_sel_hi:[1,0]
    v_pk_mul_f32 v[50:51], v[162:163], v[56:57] op_sel_hi:[1,0]
    v_xor_b32 v164, s68, v164
    v_xor_b32 v166, s68, v166
    v_pk_fma_f32 v[48:49], v[164:165], v[58:59], v[48:49] op_sel_hi:[1,0,1]
    v_pk_fma_f32 v[50:51], v[166:167], v[58:59], v[50:51] op_sel_hi:[1,0,1]
    v_xor_b32 v168, s68, v168
    v_xor_b32 v170, s68, v170
    v_pk_fma_f32 v[48:49], v[168:169], v[60:61], v[48:49] op_sel_hi:[1,0,1]
    v_pk_fma_f32 v[50:51], v[170:171], v[60:61], v[50:51] op_sel_hi:[1,0,1]
    v_xor_b32 v172, s68, v172
    v_xor_b32 v174, s68, v174
    v_pk_fma_f32 v[48:49], v[172:173], v[62:63], v[48:49] op_sel_hi:[1,0,1]
    v_pk_fma_f32 v[50:51], v[174:175], v[62:63], v[50:51] op_sel_hi:[1,0,1]
    s_nop 0
    v_add_f32_dpp v48, v48, v48 row_ror:4 row_mask:0xf bank_mask:0xf
    v_add_f32_dpp v49, v49, v49 row_ror:4 row_mask:0xf bank_mask:0xf
    v_add_f32_dpp v50, v50, v50 row_ror:4 row_mask:0xf bank_mask:0xf
    v_add_f32_dpp v51, v51, v51 row_ror:4 row_mask:0xf bank_mask:0xf
    v_add_f32_dpp v48, v48, v48 row_ror:8 row_mask:0xf bank_mask:0xf
    v_add_f32_dpp v49, v49, v49 row_ror:8 row_mask:0xf bank_mask:0xf
    v_add_f32_dpp v50, v50, v50 row_ror:8 row_mask:0xf bank_mask:0xf
    v_add_f32_dpp v51, v51, v51 row_ror:8 row_mask:0xf bank_mask:0xf
    s_mov_b32 exec_lo, 0x000f000f
    s_mov_b32 exec_hi, 0x000f000f
    v_cvt_pk_bf16_f32 v224, v48, v49
    v_cvt_pk_bf16_f32 v225, v50, v51
    global_store_dwordx2 v29, v[224:225], s[14:15]
    s_branch L_post
L_final1:
    v_xor_b32 v192, s68, v192
    v_xor_b32 v194, s68, v194
    v_pk_mul_f32 v[48:49], v[192:193], v[56:57] op_sel_hi:[1,0]
    v_pk_mul_f32 v[50:51], v[194:195], v[56:57] op_sel_hi:[1,0]
    v_xor_b32 v196, s68, v196
    v_xor_b32 v198, s68, v198
    v_pk_fma_f32 v[48:49], v[196:197], v[58:59], v[48:49] op_sel_hi:[1,0,1]
    v_pk_fma_f32 v[50:51], v[198:199], v[58:59], v[50:51] op_sel_hi:[1,0,1]
    v_xor_b32 v200, s68, v200
    v_xor_b32 v202, s68, v202
    v_pk_fma_f32 v[48:49], v[200:201], v[60:61], v[48:49] op_sel_hi:[1,0,1]
    v_pk_fma_f32 v[50:51], v[202:203], v[60:61], v[50:51] op_sel_hi:[1,0,1]
    v_xor_b32 v204, s68, v204
    v_xor_b32 v206, s68, v206
    v_pk_fma_f32 v[48:49], v[204:205], v[62:63], v[48:49] op_sel_hi:[1,0,1]
    v_pk_fma_f32 v[50:51], v[206:207], v[62:63], v[50:51] op_sel_hi:[1,0,1]
    s_nop 0
    v_add_f32_dpp v48, v48, v48 row_ror:4 row_mask:0xf bank_mask:0xf
    v_add_f32_dpp v49, v49, v49 row_ror:4 row_mask:0xf bank_mask:0xf
    v_add_f32_dpp v50, v50, v50 row_ror:4 row_mask:0xf bank_mask:0xf
    v_add_f32_dpp v51, v51, v51 row_ror:4 row_mask:0xf bank_mask:0xf
    v_add_f32_dpp v48, v48, v48 row_ror:8 row_mask:0xf bank_mask:0xf
    v_add_f32_dpp v49, v49, v49 row_ror:8 row_mask:0xf bank_mask:0xf
    v_add_f32_dpp v50, v50, v50 row_ror:8 row_mask:0xf bank_mask:0xf
    v_add_f32_dpp v51, v51, v51 row_ror:8 row_mask:0xf bank_mask:0xf
    s_mov_b32 exec_lo, 0x000f000f
    s_mov_b32 exec_hi, 0x000f000f
    v_cvt_pk_bf16_f32 v224, v48, v49
    v_cvt_pk_bf16_f32 v225, v50, v51
    global_store_dwordx2 v29, v[224:225], s[14:15]
L_post:
    s_or_b32 s49, s37, s33
    s_cbranch_scc1 L_fin
    s_mov_b64 exec, -1
    v_and_b32 v30, 31, v1
    s_lshl_b32 s49, s32, 12
    s_add_u32 s49, s49, 2097164
    v_lshl_add_u32 v31, v30, 4, s49
    v_cmp_le_u32 vcc, 9, v30
    v_add_u32 v34, 2048, v31
    s_nop 0
    v_cndmask_b32 v31, v31, v34, vcc
    v_cmp_le_u32 vcc, 15, v30
    v_add_u32 v34, -2048, v31
    s_nop 0
    v_cndmask_b32 v31, v31, v34, vcc
    v_cmp_le_u32 vcc, 22, v30
    v_add_u32 v34, 1024, v31
    s_nop 0
    v_cndmask_b32 v31, v31, v34, vcc
    v_cmp_le_u32 vcc, 27, v30
    v_add_u32 v34, 2048, v31
    s_nop 0
    v_cndmask_b32 v31, v31, v34, vcc
L_ep:
    s_sub_u32 s35, s35, 1
    s_cbranch_scc1 L_fin
    global_load_dword v34, v31, s[18:19] sc1
    s_waitcnt vmcnt(0)
    v_cmp_ne_u32 vcc, s30, v34
    s_nop 1
    s_cbranch_vccnz L_ep
    s_mov_b64 exec, 1
    global_store_dword v25, v46, s[18:19] offset:1024
L_fin:
    s_endpgm
.p2align 12
T_sh0:
    s_branch L_touch_ret
L_sh_v:
    v_and_b32_dpp v48, v224, v20 quad_perm:[0,0,0,0] row_mask:0xf bank_mask:0xf
    v_and_b32_dpp v49, v224, v21 quad_perm:[0,0,0,0] row_mask:0xf bank_mask:0xf
    v_and_b32_dpp v50, v224, v22 quad_perm:[0,0,0,0] row_mask:0xf bank_mask:0xf
    v_and_b32_dpp v51, v224, v23 quad_perm:[0,0,0,0] row_mask:0xf bank_mask:0xf
    v_and_b32_dpp v52, v224, v20 quad_perm:[1,1,1,1] row_mask:0xf bank_mask:0xf
    v_and_b32_dpp v53, v224, v21 quad_perm:[1,1,1,1] row_mask:0xf bank_mask:0xf
    v_and_b32_dpp v54, v224, v22 quad_perm:[1,1,1,1] row_mask:0xf bank_mask:0xf
    v_and_b32_dpp v55, v224, v23 quad_perm:[1,1,1,1] row_mask:0xf bank_mask:0xf
    v_and_b32_dpp v56, v224, v20 quad_perm:[2,2,2,2] row_mask:0xf bank_mask:0xf
    v_and_b32_dpp v57, v224, v21 quad_perm:[2,2,2,2] row_mask:0xf bank_mask:0xf
    v_and_b32_dpp v58, v224, v22 quad_perm:[2,2,2,2] row_mask:0xf bank_mask:0xf
    v_and_b32_dpp v59, v224, v23 quad_perm:[2,2,2,2] row_mask:0xf bank_mask:0xf
    v_and_b32_dpp v60, v224, v20 quad_perm:[3,3,3,3] row_mask:0xf bank_mask:0xf
    v_and_b32_dpp v61, v224, v21 quad_perm:[3,3,3,3] row_mask:0xf bank_mask:0xf
    v_and_b32_dpp v62, v224, v22 quad_perm:[3,3,3,3] row_mask:0xf bank_mask:0xf
    v_and_b32_dpp v63, v224, v23 quad_perm:[3,3,3,3] row_mask:0xf bank_mask:0xf
    s_waitcnt vmcnt(14)
    s_nop 0
    v_mfma_f32_16x16x32_bf16 v[192:195], v[48:51], v[96:99], v[192:195]
    v_and_b32_dpp v64, v225, v20 quad_perm:[0,0,0,0] row_mask:0xf bank_mask:0xf
    v_and_b32_dpp v65, v225, v21 quad_perm:[0,0,0,0] row_mask:0xf bank_mask:0xf
    v_mfma_f32_16x16x32_bf16 v[200:203], v[52:55], v[96:99], v[200:203]
    v_and_b32_dpp v66, v225, v22 quad_perm:[0,0,0,0] row_mask:0xf bank_mask:0xf
    v_and_b32_dpp v67, v225, v23 quad_perm:[0,0,0,0] row_mask:0xf bank_mask:0xf
    v_mfma_f32_16x16x32_bf16 v[208:211], v[56:59], v[96:99], v[208:211]
    v_and_b32_dpp v68, v225, v20 quad_perm:[1,1,1,1] row_mask:0xf bank_mask:0xf
    v_and_b32_dpp v69, v225, v21 quad_perm:[1,1,1,1] row_mask:0xf bank_mask:0xf
    v_mfma_f32_16x16x32_bf16 v[216:219], v[60:63], v[96:99], v[216:219]
    v_and_b32_dpp v70, v225, v22 quad_perm:[1,1,1,1] row_mask:0xf bank_mask:0xf
    v_and_b32_dpp v71, v225, v23 quad_perm:[1,1,1,1] row_mask:0xf bank_mask:0xf
    v_mfma_f32_16x16x32_bf16 v[196:199], v[48:51], v[100:103], v[196:199]
    v_and_b32_dpp v72, v225, v20 quad_perm:[2,2,2,2] row_mask:0xf bank_mask:0xf
    v_and_b32_dpp v73, v225, v21 quad_perm:[2,2,2,2] row_mask:0xf bank_mask:0xf
    v_mfma_f32_16x16x32_bf16 v[204:207], v[52:55], v[100:103], v[204:207]
    v_and_b32_dpp v74, v225, v22 quad_perm:[2,2,2,2] row_mask:0xf bank_mask:0xf
    v_and_b32_dpp v75, v225, v23 quad_perm:[2,2,2,2] row_mask:0xf bank_mask:0xf
    v_mfma_f32_16x16x32_bf16 v[212:215], v[56:59], v[100:103], v[212:215]
    v_and_b32_dpp v76, v225, v20 quad_perm:[3,3,3,3] row_mask:0xf bank_mask:0xf
    v_and_b32_dpp v77, v225, v21 quad_perm:[3,3,3,3] row_mask:0xf bank_mask:0xf
    v_mfma_f32_16x16x32_bf16 v[220:223], v[60:63], v[100:103], v[220:223]
    v_and_b32_dpp v78, v225, v22 quad_perm:[3,3,3,3] row_mask:0xf bank_mask:0xf
    v_and_b32_dpp v79, v225, v23 quad_perm:[3,3,3,3] row_mask:0xf bank_mask:0xf
    s_mov_b32 s26, s82
    buffer_load_dwordx4 v[96:99], v12, s[24:27], s78 offen offset:0 nt
    buffer_load_dwordx4 v[100:103], v12, s[24:27], s78 offen offset:256 nt
    s_waitcnt vmcnt(14)
    v_mfma_f32_16x16x32_bf16 v[192:195], v[64:67], v[104:107], v[192:195]
    v_and_b32_dpp v48, v226, v20 quad_perm:[0,0,0,0] row_mask:0xf bank_mask:0xf
    v_and_b32_dpp v49, v226, v21 quad_perm:[0,0,0,0] row_mask:0xf bank_mask:0xf
    v_mfma_f32_16x16x32_bf16 v[200:203], v[68:71], v[104:107], v[200:203]
    v_and_b32_dpp v50, v226, v22 quad_perm:[0,0,0,0] row_mask:0xf bank_mask:0xf
    v_and_b32_dpp v51, v226, v23 quad_perm:[0,0,0,0] row_mask:0xf bank_mask:0xf
    v_mfma_f32_16x16x32_bf16 v[208:211], v[72:75], v[104:107], v[208:211]
    v_and_b32_dpp v52, v226, v20 quad_perm:[1,1,1,1] row_mask:0xf bank_mask:0xf
    v_and_b32_dpp v53, v226, v21 quad_perm:[1,1,1,1] row_mask:0xf bank_mask:0xf
    v_mfma_f32_16x16x32_bf16 v[216:219], v[76:79], v[104:107], v[216:219]
    v_and_b32_dpp v54, v226, v22 quad_perm:[1,1,1,1] row_mask:0xf bank_mask:0xf
    v_and_b32_dpp v55, v226, v23 quad_perm:[1,1,1,1] row_mask:0xf bank_mask:0xf
    v_mfma_f32_16x16x32_bf16 v[196:199], v[64:67], v[108:111], v[196:199]
    v_and_b32_dpp v56, v226, v20 quad_perm:[2,2,2,2] row_mask:0xf bank_mask:0xf
    v_and_b32_dpp v57, v226, v21 quad_perm:[2,2,2,2] row_mask:0xf bank_mask:0xf
    v_mfma_f32_16x16x32_bf16 v[204:207], v[68:71], v[108:111], v[204:207]
    v_and_b32_dpp v58, v226, v22 quad_perm:[2,2,2,2] row_mask:0xf bank_mask:0xf
    v_and_b32_dpp v59, v226, v23 quad_perm:[2,2,2,2] row_mask:0xf bank_mask:0xf
    v_mfma_f32_16x16x32_bf16 v[212:215], v[72:75], v[108:111], v[212:215]
    v_and_b32_dpp v60, v226, v20 quad_perm:[3,3,3,3] row_mask:0xf bank_mask:0xf
    v_and_b32_dpp v61, v226, v21 quad_perm:[3,3,3,3] row_mask:0xf bank_mask:0xf
    v_mfma_f32_16x16x32_bf16 v[220:223], v[76:79], v[108:111], v[220:223]
    v_and_b32_dpp v62, v226, v22 quad_perm:[3,3,3,3] row_mask:0xf bank_mask:0xf
    v_and_b32_dpp v63, v226, v23 quad_perm:[3,3,3,3] row_mask:0xf bank_mask:0xf
    buffer_load_dwordx4 v[104:107], v13, s[24:27], s78 offen offset:0 nt
    buffer_load_dwordx4 v[108:111], v13, s[24:27], s78 offen offset:256 nt
    s_waitcnt vmcnt(14)
    v_mfma_f32_16x16x32_bf16 v[192:195], v[48:51], v[112:115], v[192:195]
    v_and_b32_dpp v64, v227, v20 quad_perm:[0,0,0,0] row_mask:0xf bank_mask:0xf
    v_and_b32_dpp v65, v227, v21 quad_perm:[0,0,0,0] row_mask:0xf bank_mask:0xf
    v_mfma_f32_16x16x32_bf16 v[200:203], v[52:55], v[112:115], v[200:203]
    v_and_b32_dpp v66, v227, v22 quad_perm:[0,0,0,0] row_mask:0xf bank_mask:0xf
    v_and_b32_dpp v67, v227, v23 quad_perm:[0,0,0,0] row_mask:0xf bank_mask:0xf
    v_mfma_f32_16x16x32_bf16 v[208:211], v[56:59], v[112:115], v[208:211]
    v_and_b32_dpp v68, v227, v20 quad_perm:[1,1,1,1] row_mask:0xf bank_mask:0xf
    v_and_b32_dpp v69, v227, v21 quad_perm:[1,1,1,1] row_mask:0xf bank_mask:0xf
    v_mfma_f32_16x16x32_bf16 v[216:219], v[60:63], v[112:115], v[216:219]
    v_and_b32_dpp v70, v227, v22 quad_perm:[1,1,1,1] row_mask:0xf bank_mask:0xf
    v_and_b32_dpp v71, v227, v23 quad_perm:[1,1,1,1] row_mask:0xf bank_mask:0xf
    v_mfma_f32_16x16x32_bf16 v[196:199], v[48:51], v[116:119], v[196:199]
    v_and_b32_dpp v72, v227, v20 quad_perm:[2,2,2,2] row_mask:0xf bank_mask:0xf
    v_and_b32_dpp v73, v227, v21 quad_perm:[2,2,2,2] row_mask:0xf bank_mask:0xf
    v_mfma_f32_16x16x32_bf16 v[204:207], v[52:55], v[116:119], v[204:207]
    v_and_b32_dpp v74, v227, v22 quad_perm:[2,2,2,2] row_mask:0xf bank_mask:0xf
    v_and_b32_dpp v75, v227, v23 quad_perm:[2,2,2,2] row_mask:0xf bank_mask:0xf
    v_mfma_f32_16x16x32_bf16 v[212:215], v[56:59], v[116:119], v[212:215]
    v_and_b32_dpp v76, v227, v20 quad_perm:[3,3,3,3] row_mask:0xf bank_mask:0xf
    v_and_b32_dpp v77, v227, v21 quad_perm:[3,3,3,3] row_mask:0xf bank_mask:0xf
    v_mfma_f32_16x16x32_bf16 v[220:223], v[60:63], v[116:119], v[220:223]
    v_and_b32_dpp v78, v227, v22 quad_perm:[3,3,3,3] row_mask:0xf bank_mask:0xf
    v_and_b32_dpp v79, v227, v23 quad_perm:[3,3,3,3] row_mask:0xf bank_mask:0xf
    buffer_load_dwordx4 v[112:115], v14, s[24:27], s78 offen offset:0 nt
    buffer_load_dwordx4 v[116:119], v14, s[24:27], s78 offen offset:256 nt
    s_waitcnt vmcnt(14)
    v_mfma_f32_16x16x32_bf16 v[192:195], v[64:67], v[120:123], v[192:195]
    v_and_b32_dpp v48, v228, v20 quad_perm:[0,0,0,0] row_mask:0xf bank_mask:0xf
    v_and_b32_dpp v49, v228, v21 quad_perm:[0,0,0,0] row_mask:0xf bank_mask:0xf
    v_mfma_f32_16x16x32_bf16 v[200:203], v[68:71], v[120:123], v[200:203]
    v_and_b32_dpp v50, v228, v22 quad_perm:[0,0,0,0] row_mask:0xf bank_mask:0xf
    v_and_b32_dpp v51, v228, v23 quad_perm:[0,0,0,0] row_mask:0xf bank_mask:0xf
    v_mfma_f32_16x16x32_bf16 v[208:211], v[72:75], v[120:123], v[208:211]
    v_and_b32_dpp v52, v228, v20 quad_perm:[1,1,1,1] row_mask:0xf bank_mask:0xf
    v_and_b32_dpp v53, v228, v21 quad_perm:[1,1,1,1] row_mask:0xf bank_mask:0xf
    v_mfma_f32_16x16x32_bf16 v[216:219], v[76:79], v[120:123], v[216:219]
    v_and_b32_dpp v54, v228, v22 quad_perm:[1,1,1,1] row_mask:0xf bank_mask:0xf
    v_and_b32_dpp v55, v228, v23 quad_perm:[1,1,1,1] row_mask:0xf bank_mask:0xf
    v_mfma_f32_16x16x32_bf16 v[196:199], v[64:67], v[124:127], v[196:199]
    v_and_b32_dpp v56, v228, v20 quad_perm:[2,2,2,2] row_mask:0xf bank_mask:0xf
    v_and_b32_dpp v57, v228, v21 quad_perm:[2,2,2,2] row_mask:0xf bank_mask:0xf
    v_mfma_f32_16x16x32_bf16 v[204:207], v[68:71], v[124:127], v[204:207]
    v_and_b32_dpp v58, v228, v22 quad_perm:[2,2,2,2] row_mask:0xf bank_mask:0xf
    v_and_b32_dpp v59, v228, v23 quad_perm:[2,2,2,2] row_mask:0xf bank_mask:0xf
    v_mfma_f32_16x16x32_bf16 v[212:215], v[72:75], v[124:127], v[212:215]
    v_and_b32_dpp v60, v228, v20 quad_perm:[3,3,3,3] row_mask:0xf bank_mask:0xf
    v_and_b32_dpp v61, v228, v21 quad_perm:[3,3,3,3] row_mask:0xf bank_mask:0xf
    v_mfma_f32_16x16x32_bf16 v[220:223], v[76:79], v[124:127], v[220:223]
    v_and_b32_dpp v62, v228, v22 quad_perm:[3,3,3,3] row_mask:0xf bank_mask:0xf
    v_and_b32_dpp v63, v228, v23 quad_perm:[3,3,3,3] row_mask:0xf bank_mask:0xf
    buffer_load_dwordx4 v[120:123], v15, s[24:27], s78 offen offset:0 nt
    buffer_load_dwordx4 v[124:127], v15, s[24:27], s78 offen offset:256 nt
    s_branch L_sh_u1
T_sh1:
    s_branch L_touch_ret
L_sh_u1:
    s_waitcnt vmcnt(14)
    v_mfma_f32_16x16x32_bf16 v[192:195], v[48:51], v[128:131], v[192:195]
    v_and_b32_dpp v64, v229, v20 quad_perm:[0,0,0,0] row_mask:0xf bank_mask:0xf
    v_and_b32_dpp v65, v229, v21 quad_perm:[0,0,0,0] row_mask:0xf bank_mask:0xf
    v_mfma_f32_16x16x32_bf16 v[200:203], v[52:55], v[128:131], v[200:203]
    v_and_b32_dpp v66, v229, v22 quad_perm:[0,0,0,0] row_mask:0xf bank_mask:0xf
    v_and_b32_dpp v67, v229, v23 quad_perm:[0,0,0,0] row_mask:0xf bank_mask:0xf
    v_mfma_f32_16x16x32_bf16 v[208:211], v[56:59], v[128:131], v[208:211]
    v_and_b32_dpp v68, v229, v20 quad_perm:[1,1,1,1] row_mask:0xf bank_mask:0xf
    v_and_b32_dpp v69, v229, v21 quad_perm:[1,1,1,1] row_mask:0xf bank_mask:0xf
    v_mfma_f32_16x16x32_bf16 v[216:219], v[60:63], v[128:131], v[216:219]
    v_and_b32_dpp v70, v229, v22 quad_perm:[1,1,1,1] row_mask:0xf bank_mask:0xf
    v_and_b32_dpp v71, v229, v23 quad_perm:[1,1,1,1] row_mask:0xf bank_mask:0xf
    v_mfma_f32_16x16x32_bf16 v[196:199], v[48:51], v[132:135], v[196:199]
    v_and_b32_dpp v72, v229, v20 quad_perm:[2,2,2,2] row_mask:0xf bank_mask:0xf
    v_and_b32_dpp v73, v229, v21 quad_perm:[2,2,2,2] row_mask:0xf bank_mask:0xf
    v_mfma_f32_16x16x32_bf16 v[204:207], v[52:55], v[132:135], v[204:207]
    v_and_b32_dpp v74, v229, v22 quad_perm:[2,2,2,2] row_mask:0xf bank_mask:0xf
    v_and_b32_dpp v75, v229, v23 quad_perm:[2,2,2,2] row_mask:0xf bank_mask:0xf
    v_mfma_f32_16x16x32_bf16 v[212:215], v[56:59], v[132:135], v[212:215]
    v_and_b32_dpp v76, v229, v20 quad_perm:[3,3,3,3] row_mask:0xf bank_mask:0xf
    v_and_b32_dpp v77, v229, v21 quad_perm:[3,3,3,3] row_mask:0xf bank_mask:0xf
    v_mfma_f32_16x16x32_bf16 v[220:223], v[60:63], v[132:135], v[220:223]
    v_and_b32_dpp v78, v229, v22 quad_perm:[3,3,3,3] row_mask:0xf bank_mask:0xf
    v_and_b32_dpp v79, v229, v23 quad_perm:[3,3,3,3] row_mask:0xf bank_mask:0xf
    s_mov_b32 s26, s83
    buffer_load_dwordx4 v[128:131], v12, s[24:27], s79 offen offset:0 nt
    buffer_load_dwordx4 v[132:135], v12, s[24:27], s79 offen offset:256 nt
    s_waitcnt vmcnt(14)
    v_mfma_f32_16x16x32_bf16 v[192:195], v[64:67], v[136:139], v[192:195]
    v_and_b32_dpp v48, v230, v20 quad_perm:[0,0,0,0] row_mask:0xf bank_mask:0xf
    v_and_b32_dpp v49, v230, v21 quad_perm:[0,0,0,0] row_mask:0xf bank_mask:0xf
    v_mfma_f32_16x16x32_bf16 v[200:203], v[68:71], v[136:139], v[200:203]
    v_and_b32_dpp v50, v230, v22 quad_perm:[0,0,0,0] row_mask:0xf bank_mask:0xf
    v_and_b32_dpp v51, v230, v23 quad_perm:[0,0,0,0] row_mask:0xf bank_mask:0xf
    v_mfma_f32_16x16x32_bf16 v[208:211], v[72:75], v[136:139], v[208:211]
    v_and_b32_dpp v52, v230, v20 quad_perm:[1,1,1,1] row_mask:0xf bank_mask:0xf
    v_and_b32_dpp v53, v230, v21 quad_perm:[1,1,1,1] row_mask:0xf bank_mask:0xf
    v_mfma_f32_16x16x32_bf16 v[216:219], v[76:79], v[136:139], v[216:219]
    v_and_b32_dpp v54, v230, v22 quad_perm:[1,1,1,1] row_mask:0xf bank_mask:0xf
    v_and_b32_dpp v55, v230, v23 quad_perm:[1,1,1,1] row_mask:0xf bank_mask:0xf
    v_mfma_f32_16x16x32_bf16 v[196:199], v[64:67], v[140:143], v[196:199]
    v_and_b32_dpp v56, v230, v20 quad_perm:[2,2,2,2] row_mask:0xf bank_mask:0xf
    v_and_b32_dpp v57, v230, v21 quad_perm:[2,2,2,2] row_mask:0xf bank_mask:0xf
    v_mfma_f32_16x16x32_bf16 v[204:207], v[68:71], v[140:143], v[204:207]
    v_and_b32_dpp v58, v230, v22 quad_perm:[2,2,2,2] row_mask:0xf bank_mask:0xf
    v_and_b32_dpp v59, v230, v23 quad_perm:[2,2,2,2] row_mask:0xf bank_mask:0xf
    v_mfma_f32_16x16x32_bf16 v[212:215], v[72:75], v[140:143], v[212:215]
    v_and_b32_dpp v60, v230, v20 quad_perm:[3,3,3,3] row_mask:0xf bank_mask:0xf
    v_and_b32_dpp v61, v230, v21 quad_perm:[3,3,3,3] row_mask:0xf bank_mask:0xf
    v_mfma_f32_16x16x32_bf16 v[220:223], v[76:79], v[140:143], v[220:223]
    v_and_b32_dpp v62, v230, v22 quad_perm:[3,3,3,3] row_mask:0xf bank_mask:0xf
    v_and_b32_dpp v63, v230, v23 quad_perm:[3,3,3,3] row_mask:0xf bank_mask:0xf
    buffer_load_dwordx4 v[136:139], v13, s[24:27], s79 offen offset:0 nt
    buffer_load_dwordx4 v[140:143], v13, s[24:27], s79 offen offset:256 nt
    s_waitcnt vmcnt(14)
    v_mfma_f32_16x16x32_bf16 v[192:195], v[48:51], v[144:147], v[192:195]
    v_and_b32_dpp v64, v231, v20 quad_perm:[0,0,0,0] row_mask:0xf bank_mask:0xf
    v_and_b32_dpp v65, v231, v21 quad_perm:[0,0,0,0] row_mask:0xf bank_mask:0xf
    v_mfma_f32_16x16x32_bf16 v[200:203], v[52:55], v[144:147], v[200:203]
    v_and_b32_dpp v66, v231, v22 quad_perm:[0,0,0,0] row_mask:0xf bank_mask:0xf
    v_and_b32_dpp v67, v231, v23 quad_perm:[0,0,0,0] row_mask:0xf bank_mask:0xf
    v_mfma_f32_16x16x32_bf16 v[208:211], v[56:59], v[144:147], v[208:211]
    v_and_b32_dpp v68, v231, v20 quad_perm:[1,1,1,1] row_mask:0xf bank_mask:0xf
    v_and_b32_dpp v69, v231, v21 quad_perm:[1,1,1,1] row_mask:0xf bank_mask:0xf
    v_mfma_f32_16x16x32_bf16 v[216:219], v[60:63], v[144:147], v[216:219]
    v_and_b32_dpp v70, v231, v22 quad_perm:[1,1,1,1] row_mask:0xf bank_mask:0xf
    v_and_b32_dpp v71, v231, v23 quad_perm:[1,1,1,1] row_mask:0xf bank_mask:0xf
    v_mfma_f32_16x16x32_bf16 v[196:199], v[48:51], v[148:151], v[196:199]
    v_and_b32_dpp v72, v231, v20 quad_perm:[2,2,2,2] row_mask:0xf bank_mask:0xf
    v_and_b32_dpp v73, v231, v21 quad_perm:[2,2,2,2] row_mask:0xf bank_mask:0xf
    v_mfma_f32_16x16x32_bf16 v[204:207], v[52:55], v[148:151], v[204:207]
    v_and_b32_dpp v74, v231, v22 quad_perm:[2,2,2,2] row_mask:0xf bank_mask:0xf
    v_and_b32_dpp v75, v231, v23 quad_perm:[2,2,2,2] row_mask:0xf bank_mask:0xf
    v_mfma_f32_16x16x32_bf16 v[212:215], v[56:59], v[148:151], v[212:215]
    v_and_b32_dpp v76, v231, v20 quad_perm:[3,3,3,3] row_mask:0xf bank_mask:0xf
    v_and_b32_dpp v77, v231, v21 quad_perm:[3,3,3,3] row_mask:0xf bank_mask:0xf
    v_mfma_f32_16x16x32_bf16 v[220:223], v[60:63], v[148:151], v[220:223]
    v_and_b32_dpp v78, v231, v22 quad_perm:[3,3,3,3] row_mask:0xf bank_mask:0xf
    v_and_b32_dpp v79, v231, v23 quad_perm:[3,3,3,3] row_mask:0xf bank_mask:0xf
    buffer_load_dwordx4 v[144:147], v14, s[24:27], s79 offen offset:0 nt
    buffer_load_dwordx4 v[148:151], v14, s[24:27], s79 offen offset:256 nt
    s_waitcnt vmcnt(14)
    v_mfma_f32_16x16x32_bf16 v[192:195], v[64:67], v[152:155], v[192:195]
    v_and_b32_dpp v48, v232, v20 quad_perm:[0,0,0,0] row_mask:0xf bank_mask:0xf
    v_and_b32_dpp v49, v232, v21 quad_perm:[0,0,0,0] row_mask:0xf bank_mask:0xf
    v_mfma_f32_16x16x32_bf16 v[200:203], v[68:71], v[152:155], v[200:203]
    v_and_b32_dpp v50, v232, v22 quad_perm:[0,0,0,0] row_mask:0xf bank_mask:0xf
    v_and_b32_dpp v51, v232, v23 quad_perm:[0,0,0,0] row_mask:0xf bank_mask:0xf
    v_mfma_f32_16x16x32_bf16 v[208:211], v[72:75], v[152:155], v[208:211]
    v_and_b32_dpp v52, v232, v20 quad_perm:[1,1,1,1] row_mask:0xf bank_mask:0xf
    v_and_b32_dpp v53, v232, v21 quad_perm:[1,1,1,1] row_mask:0xf bank_mask:0xf
    v_mfma_f32_16x16x32_bf16 v[216:219], v[76:79], v[152:155], v[216:219]
    v_and_b32_dpp v54, v232, v22 quad_perm:[1,1,1,1] row_mask:0xf bank_mask:0xf
    v_and_b32_dpp v55, v232, v23 quad_perm:[1,1,1,1] row_mask:0xf bank_mask:0xf
    v_mfma_f32_16x16x32_bf16 v[196:199], v[64:67], v[156:159], v[196:199]
    v_and_b32_dpp v56, v232, v20 quad_perm:[2,2,2,2] row_mask:0xf bank_mask:0xf
    v_and_b32_dpp v57, v232, v21 quad_perm:[2,2,2,2] row_mask:0xf bank_mask:0xf
    v_mfma_f32_16x16x32_bf16 v[204:207], v[68:71], v[156:159], v[204:207]
    v_and_b32_dpp v58, v232, v22 quad_perm:[2,2,2,2] row_mask:0xf bank_mask:0xf
    v_and_b32_dpp v59, v232, v23 quad_perm:[2,2,2,2] row_mask:0xf bank_mask:0xf
    v_mfma_f32_16x16x32_bf16 v[212:215], v[72:75], v[156:159], v[212:215]
    v_and_b32_dpp v60, v232, v20 quad_perm:[3,3,3,3] row_mask:0xf bank_mask:0xf
    v_and_b32_dpp v61, v232, v21 quad_perm:[3,3,3,3] row_mask:0xf bank_mask:0xf
    v_mfma_f32_16x16x32_bf16 v[220:223], v[76:79], v[156:159], v[220:223]
    v_and_b32_dpp v62, v232, v22 quad_perm:[3,3,3,3] row_mask:0xf bank_mask:0xf
    v_and_b32_dpp v63, v232, v23 quad_perm:[3,3,3,3] row_mask:0xf bank_mask:0xf
    buffer_load_dwordx4 v[152:155], v15, s[24:27], s79 offen offset:0 nt
    buffer_load_dwordx4 v[156:159], v15, s[24:27], s79 offen offset:256 nt
    s_branch L_sh_u2
T_sh2:
    s_branch L_touch_ret
L_sh_u2:
    s_waitcnt vmcnt(14)
    v_mfma_f32_16x16x32_bf16 v[192:195], v[48:51], v[96:99], v[192:195]
    v_and_b32_dpp v64, v233, v20 quad_perm:[0,0,0,0] row_mask:0xf bank_mask:0xf
    v_and_b32_dpp v65, v233, v21 quad_perm:[0,0,0,0] row_mask:0xf bank_mask:0xf
    v_mfma_f32_16x16x32_bf16 v[200:203], v[52:55], v[96:99], v[200:203]
    v_and_b32_dpp v66, v233, v22 quad_perm:[0,0,0,0] row_mask:0xf bank_mask:0xf
    v_and_b32_dpp v67, v233, v23 quad_perm:[0,0,0,0] row_mask:0xf bank_mask:0xf
    v_mfma_f32_16x16x32_bf16 v[208:211], v[56:59], v[96:99], v[208:211]
    v_and_b32_dpp v68, v233, v20 quad_perm:[1,1,1,1] row_mask:0xf bank_mask:0xf
    v_and_b32_dpp v69, v233, v21 quad_perm:[1,1,1,1] row_mask:0xf bank_mask:0xf
    v_mfma_f32_16x16x32_bf16 v[216:219], v[60:63], v[96:99], v[216:219]
    v_and_b32_dpp v70, v233, v22 quad_perm:[1,1,1,1] row_mask:0xf bank_mask:0xf
    v_and_b32_dpp v71, v233, v23 quad_perm:[1,1,1,1] row_mask:0xf bank_mask:0xf
    v_mfma_f32_16x16x32_bf16 v[196:199], v[48:51], v[100:103], v[196:199]
    v_and_b32_dpp v72, v233, v20 quad_perm:[2,2,2,2] row_mask:0xf bank_mask:0xf
    v_and_b32_dpp v73, v233, v21 quad_perm:[2,2,2,2] row_mask:0xf bank_mask:0xf
    v_mfma_f32_16x16x32_bf16 v[204:207], v[52:55], v[100:103], v[204:207]
    v_and_b32_dpp v74, v233, v22 quad_perm:[2,2,2,2] row_mask:0xf bank_mask:0xf
    v_and_b32_dpp v75, v233, v23 quad_perm:[2,2,2,2] row_mask:0xf bank_mask:0xf
    v_mfma_f32_16x16x32_bf16 v[212:215], v[56:59], v[100:103], v[212:215]
    v_and_b32_dpp v76, v233, v20 quad_perm:[3,3,3,3] row_mask:0xf bank_mask:0xf
    v_and_b32_dpp v77, v233, v21 quad_perm:[3,3,3,3] row_mask:0xf bank_mask:0xf
    v_mfma_f32_16x16x32_bf16 v[220:223], v[60:63], v[100:103], v[220:223]
    v_and_b32_dpp v78, v233, v22 quad_perm:[3,3,3,3] row_mask:0xf bank_mask:0xf
    v_and_b32_dpp v79, v233, v23 quad_perm:[3,3,3,3] row_mask:0xf bank_mask:0xf
    s_waitcnt vmcnt(12)
    v_mfma_f32_16x16x32_bf16 v[192:195], v[64:67], v[104:107], v[192:195]
    v_and_b32_dpp v48, v234, v20 quad_perm:[0,0,0,0] row_mask:0xf bank_mask:0xf
    v_and_b32_dpp v49, v234, v21 quad_perm:[0,0,0,0] row_mask:0xf bank_mask:0xf
    v_mfma_f32_16x16x32_bf16 v[200:203], v[68:71], v[104:107], v[200:203]
    v_and_b32_dpp v50, v234, v22 quad_perm:[0,0,0,0] row_mask:0xf bank_mask:0xf
    v_and_b32_dpp v51, v234, v23 quad_perm:[0,0,0,0] row_mask:0xf bank_mask:0xf
    v_mfma_f32_16x16x32_bf16 v[208:211], v[72:75], v[104:107], v[208:211]
    v_and_b32_dpp v52, v234, v20 quad_perm:[1,1,1,1] row_mask:0xf bank_mask:0xf
    v_and_b32_dpp v53, v234, v21 quad_perm:[1,1,1,1] row_mask:0xf bank_mask:0xf
    v_mfma_f32_16x16x32_bf16 v[216:219], v[76:79], v[104:107], v[216:219]
    v_and_b32_dpp v54, v234, v22 quad_perm:[1,1,1,1] row_mask:0xf bank_mask:0xf
    v_and_b32_dpp v55, v234, v23 quad_perm:[1,1,1,1] row_mask:0xf bank_mask:0xf
    v_mfma_f32_16x16x32_bf16 v[196:199], v[64:67], v[108:111], v[196:199]
    v_and_b32_dpp v56, v234, v20 quad_perm:[2,2,2,2] row_mask:0xf bank_mask:0xf
    v_and_b32_dpp v57, v234, v21 quad_perm:[2,2,2,2] row_mask:0xf bank_mask:0xf
    v_mfma_f32_16x16x32_bf16 v[204:207], v[68:71], v[108:111], v[204:207]
    v_and_b32_dpp v58, v234, v22 quad_perm:[2,2,2,2] row_mask:0xf bank_mask:0xf
    v_and_b32_dpp v59, v234, v23 quad_perm:[2,2,2,2] row_mask:0xf bank_mask:0xf
    v_mfma_f32_16x16x32_bf16 v[212:215], v[72:75], v[108:111], v[212:215]
    v_and_b32_dpp v60, v234, v20 quad_perm:[3,3,3,3] row_mask:0xf bank_mask:0xf
    v_and_b32_dpp v61, v234, v21 quad_perm:[3,3,3,3] row_mask:0xf bank_mask:0xf
    v_mfma_f32_16x16x32_bf16 v[220:223], v[76:79], v[108:111], v[220:223]
    v_and_b32_dpp v62, v234, v22 quad_perm:[3,3,3,3] row_mask:0xf bank_mask:0xf
    v_and_b32_dpp v63, v234, v23 quad_perm:[3,3,3,3] row_mask:0xf bank_mask:0xf
    s_waitcnt vmcnt(10)
    v_mfma_f32_16x16x32_bf16 v[192:195], v[48:51], v[112:115], v[192:195]
    v_and_b32_dpp v64, v235, v20 quad_perm:[0,0,0,0] row_mask:0xf bank_mask:0xf
    v_and_b32_dpp v65, v235, v21 quad_perm:[0,0,0,0] row_mask:0xf bank_mask:0xf
    v_mfma_f32_16x16x32_bf16 v[200:203], v[52:55], v[112:115], v[200:203]
    v_and_b32_dpp v66, v235, v22 quad_perm:[0,0,0,0] row_mask:0xf bank_mask:0xf
    v_and_b32_dpp v67, v235, v23 quad_perm:[0,0,0,0] row_mask:0xf bank_mask:0xf
    v_mfma_f32_16x16x32_bf16 v[208:211], v[56:59], v[112:115], v[208:211]
    v_and_b32_dpp v68, v235, v20 quad_perm:[1,1,1,1] row_mask:0xf bank_mask:0xf
    v_and_b32_dpp v69, v235, v21 quad_perm:[1,1,1,1] row_mask:0xf bank_mask:0xf
    v_mfma_f32_16x16x32_bf16 v[216:219], v[60:63], v[112:115], v[216:219]
    v_and_b32_dpp v70, v235, v22 quad_perm:[1,1,1,1] row_mask:0xf bank_mask:0xf
    v_and_b32_dpp v71, v235, v23 quad_perm:[1,1,1,1] row_mask:0xf bank_mask:0xf
    v_mfma_f32_16x16x32_bf16 v[196:199], v[48:51], v[116:119], v[196:199]
    v_and_b32_dpp v72, v235, v20 quad_perm:[2,2,2,2] row_mask:0xf bank_mask:0xf
    v_and_b32_dpp v73, v235, v21 quad_perm:[2,2,2,2] row_mask:0xf bank_mask:0xf
    v_mfma_f32_16x16x32_bf16 v[204:207], v[52:55], v[116:119], v[204:207]
    v_and_b32_dpp v74, v235, v22 quad_perm:[2,2,2,2] row_mask:0xf bank_mask:0xf
    v_and_b32_dpp v75, v235, v23 quad_perm:[2,2,2,2] row_mask:0xf bank_mask:0xf
    v_mfma_f32_16x16x32_bf16 v[212:215], v[56:59], v[116:119], v[212:215]
    v_and_b32_dpp v76, v235, v20 quad_perm:[3,3,3,3] row_mask:0xf bank_mask:0xf
    v_and_b32_dpp v77, v235, v21 quad_perm:[3,3,3,3] row_mask:0xf bank_mask:0xf
    v_mfma_f32_16x16x32_bf16 v[220:223], v[60:63], v[116:119], v[220:223]
    v_and_b32_dpp v78, v235, v22 quad_perm:[3,3,3,3] row_mask:0xf bank_mask:0xf
    v_and_b32_dpp v79, v235, v23 quad_perm:[3,3,3,3] row_mask:0xf bank_mask:0xf
    s_waitcnt vmcnt(8)
    v_mfma_f32_16x16x32_bf16 v[192:195], v[64:67], v[120:123], v[192:195]
    v_and_b32_dpp v52, v236, v20 quad_perm:[1,1,1,1] row_mask:0xf bank_mask:0xf
    v_and_b32_dpp v53, v236, v21 quad_perm:[1,1,1,1] row_mask:0xf bank_mask:0xf
    v_mfma_f32_16x16x32_bf16 v[200:203], v[68:71], v[120:123], v[200:203]
    v_and_b32_dpp v54, v236, v22 quad_perm:[1,1,1,1] row_mask:0xf bank_mask:0xf
    v_and_b32_dpp v55, v236, v23 quad_perm:[1,1,1,1] row_mask:0xf bank_mask:0xf
    v_mfma_f32_16x16x32_bf16 v[208:211], v[72:75], v[120:123], v[208:211]
    v_and_b32_dpp v56, v236, v20 quad_perm:[2,2,2,2] row_mask:0xf bank_mask:0xf
    v_and_b32_dpp v57, v236, v21 quad_perm:[2,2,2,2] row_mask:0xf bank_mask:0xf
    v_mfma_f32_16x16x32_bf16 v[216:219], v[76:79], v[120:123], v[216:219]
    v_and_b32_dpp v58, v236, v22 quad_perm:[2,2,2,2] row_mask:0xf bank_mask:0xf
    v_and_b32_dpp v59, v236, v23 quad_perm:[2,2,2,2] row_mask:0xf bank_mask:0xf
    v_mfma_f32_16x16x32_bf16 v[196:199], v[64:67], v[124:127], v[196:199]
    v_and_b32_dpp v60, v236, v20 quad_perm:[3,3,3,3] row_mask:0xf bank_mask:0xf
    v_and_b32_dpp v61, v236, v21 quad_perm:[3,3,3,3] row_mask:0xf bank_mask:0xf
    v_mfma_f32_16x16x32_bf16 v[204:207], v[68:71], v[124:127], v[204:207]
    v_and_b32_dpp v62, v236, v22 quad_perm:[3,3,3,3] row_mask:0xf bank_mask:0xf
    v_and_b32_dpp v63, v236, v23 quad_perm:[3,3,3,3] row_mask:0xf bank_mask:0xf
    v_mfma_f32_16x16x32_bf16 v[212:215], v[72:75], v[124:127], v[212:215]
    v_and_b32_dpp v96, v236, v20 quad_perm:[0,0,0,0] row_mask:0xf bank_mask:0xf
    v_and_b32_dpp v97, v236, v21 quad_perm:[0,0,0,0] row_mask:0xf bank_mask:0xf
    v_mfma_f32_16x16x32_bf16 v[220:223], v[76:79], v[124:127], v[220:223]
    v_and_b32_dpp v98, v236, v22 quad_perm:[0,0,0,0] row_mask:0xf bank_mask:0xf
    v_and_b32_dpp v99, v236, v23 quad_perm:[0,0,0,0] row_mask:0xf bank_mask:0xf
    s_branch L_sh_u3
T_sh3:
    s_branch L_touch_ret
L_sh_u3:
    s_mov_b64 exec, s[70:71]
    global_load_dword v249, v247, s[58:59]
    s_mov_b64 exec, -1
    s_waitcnt vmcnt(7)
    v_mfma_f32_16x16x32_bf16 v[200:203], v[52:55], v[128:131], v[200:203]
    v_and_b32_dpp v68, v237, v20 quad_perm:[1,1,1,1] row_mask:0xf bank_mask:0xf
    v_and_b32_dpp v69, v237, v21 quad_perm:[1,1,1,1] row_mask:0xf bank_mask:0xf
    v_and_b32_dpp v70, v237, v22 quad_perm:[1,1,1,1] row_mask:0xf bank_mask:0xf
    v_mfma_f32_16x16x32_bf16 v[208:211], v[56:59], v[128:131], v[208:211]
    v_and_b32_dpp v71, v237, v23 quad_perm:[1,1,1,1] row_mask:0xf bank_mask:0xf
    v_and_b32_dpp v72, v237, v20 quad_perm:[2,2,2,2] row_mask:0xf bank_mask:0xf
    v_and_b32_dpp v73, v237, v21 quad_perm:[2,2,2,2] row_mask:0xf bank_mask:0xf
    v_mfma_f32_16x16x32_bf16 v[216:219], v[60:63], v[128:131], v[216:219]
    v_and_b32_dpp v74, v237, v22 quad_perm:[2,2,2,2] row_mask:0xf bank_mask:0xf
    v_and_b32_dpp v75, v237, v23 quad_perm:[2,2,2,2] row_mask:0xf bank_mask:0xf
    v_and_b32_dpp v76, v237, v20 quad_perm:[3,3,3,3] row_mask:0xf bank_mask:0xf
    v_mfma_f32_16x16x32_bf16 v[204:207], v[52:55], v[132:135], v[204:207]
    v_and_b32_dpp v77, v237, v21 quad_perm:[3,3,3,3] row_mask:0xf bank_mask:0xf
    v_and_b32_dpp v78, v237, v22 quad_perm:[3,3,3,3] row_mask:0xf bank_mask:0xf
    v_and_b32_dpp v79, v237, v23 quad_perm:[3,3,3,3] row_mask:0xf bank_mask:0xf
    v_mfma_f32_16x16x32_bf16 v[212:215], v[56:59], v[132:135], v[212:215]
    v_and_b32_dpp v100, v237, v20 quad_perm:[0,0,0,0] row_mask:0xf bank_mask:0xf
    v_and_b32_dpp v101, v237, v21 quad_perm:[0,0,0,0] row_mask:0xf bank_mask:0xf
    v_and_b32_dpp v102, v237, v22 quad_perm:[0,0,0,0] row_mask:0xf bank_mask:0xf
    v_mfma_f32_16x16x32_bf16 v[220:223], v[60:63], v[132:135], v[220:223]
    v_and_b32_dpp v103, v237, v23 quad_perm:[0,0,0,0] row_mask:0xf bank_mask:0xf
    s_waitcnt vmcnt(5)
    v_mfma_f32_16x16x32_bf16 v[200:203], v[68:71], v[136:139], v[200:203]
    v_and_b32_dpp v52, v238, v20 quad_perm:[1,1,1,1] row_mask:0xf bank_mask:0xf
    v_and_b32_dpp v53, v238, v21 quad_perm:[1,1,1,1] row_mask:0xf bank_mask:0xf
    v_and_b32_dpp v54, v238, v22 quad_perm:[1,1,1,1] row_mask:0xf bank_mask:0xf
    v_mfma_f32_16x16x32_bf16 v[208:211], v[72:75], v[136:139], v[208:211]
    v_and_b32_dpp v55, v238, v23 quad_perm:[1,1,1,1] row_mask:0xf bank_mask:0xf
    v_and_b32_dpp v56, v238, v20 quad_perm:[2,2,2,2] row_mask:0xf bank_mask:0xf
    v_and_b32_dpp v57, v238, v21 quad_perm:[2,2,2,2] row_mask:0xf bank_mask:0xf
    v_mfma_f32_16x16x32_bf16 v[216:219], v[76:79], v[136:139], v[216:219]
    v_and_b32_dpp v58, v238, v22 quad_perm:[2,2,2,2] row_mask:0xf bank_mask:0xf
    v_and_b32_dpp v59, v238, v23 quad_perm:[2,2,2,2] row_mask:0xf bank_mask:0xf
    v_and_b32_dpp v60, v238, v20 quad_perm:[3,3,3,3] row_mask:0xf bank_mask:0xf
    v_mfma_f32_16x16x32_bf16 v[204:207], v[68:71], v[140:143], v[204:207]
    v_and_b32_dpp v61, v238, v21 quad_perm:[3,3,3,3] row_mask:0xf bank_mask:0xf
    v_and_b32_dpp v62, v238, v22 quad_perm:[3,3,3,3] row_mask:0xf bank_mask:0xf
    v_and_b32_dpp v63, v238, v23 quad_perm:[3,3,3,3] row_mask:0xf bank_mask:0xf
    v_mfma_f32_16x16x32_bf16 v[212:215], v[72:75], v[140:143], v[212:215]
    v_and_b32_dpp v104, v238, v20 quad_perm:[0,0,0,0] row_mask:0xf bank_mask:0xf
    v_and_b32_dpp v105, v238, v21 quad_perm:[0,0,0,0] row_mask:0xf bank_mask:0xf
    v_and_b32_dpp v106, v238, v22 quad_perm:[0,0,0,0] row_mask:0xf bank_mask:0xf
    v_mfma_f32_16x16x32_bf16 v[220:223], v[76:79], v[140:143], v[220:223]
    v_and_b32_dpp v107, v238, v23 quad_perm:[0,0,0,0] row_mask:0xf bank_mask:0xf
    s_waitcnt vmcnt(3)
    v_mfma_f32_16x16x32_bf16 v[200:203], v[52:55], v[144:147], v[200:203]
    v_and_b32_dpp v68, v239, v20 quad_perm:[1,1,1,1] row_mask:0xf bank_mask:0xf
    v_and_b32_dpp v69, v239, v21 quad_perm:[1,1,1,1] row_mask:0xf bank_mask:0xf
    v_and_b32_dpp v70, v239, v22 quad_perm:[1,1,1,1] row_mask:0xf bank_mask:0xf
    v_mfma_f32_16x16x32_bf16 v[208:211], v[56:59], v[144:147], v[208:211]
    v_and_b32_dpp v71, v239, v23 quad_perm:[1,1,1,1] row_mask:0xf bank_mask:0xf
    v_and_b32_dpp v72, v239, v20 quad_perm:[2,2,2,2] row_mask:0xf bank_mask:0xf
    v_and_b32_dpp v73, v239, v21 quad_perm:[2,2,2,2] row_mask:0xf bank_mask:0xf
    v_mfma_f32_16x16x32_bf16 v[216:219], v[60:63], v[144:147], v[216:219]
    v_and_b32_dpp v74, v239, v22 quad_perm:[2,2,2,2] row_mask:0xf bank_mask:0xf
    v_and_b32_dpp v75, v239, v23 quad_perm:[2,2,2,2] row_mask:0xf bank_mask:0xf
    v_and_b32_dpp v76, v239, v20 quad_perm:[3,3,3,3] row_mask:0xf bank_mask:0xf
    v_mfma_f32_16x16x32_bf16 v[204:207], v[52:55], v[148:151], v[204:207]
    v_and_b32_dpp v77, v239, v21 quad_perm:[3,3,3,3] row_mask:0xf bank_mask:0xf
    v_and_b32_dpp v78, v239, v22 quad_perm:[3,3,3,3] row_mask:0xf bank_mask:0xf
    v_and_b32_dpp v79, v239, v23 quad_perm:[3,3,3,3] row_mask:0xf bank_mask:0xf
    v_mfma_f32_16x16x32_bf16 v[212:215], v[56:59], v[148:151], v[212:215]
    v_and_b32_dpp v108, v239, v20 quad_perm:[0,0,0,0] row_mask:0xf bank_mask:0xf
    v_and_b32_dpp v109, v239, v21 quad_perm:[0,0,0,0] row_mask:0xf bank_mask:0xf
    v_and_b32_dpp v110, v239, v22 quad_perm:[0,0,0,0] row_mask:0xf bank_mask:0xf
    v_mfma_f32_16x16x32_bf16 v[220:223], v[60:63], v[148:151], v[220:223]
    v_and_b32_dpp v111, v239, v23 quad_perm:[0,0,0,0] row_mask:0xf bank_mask:0xf
    s_waitcnt vmcnt(1)
    v_mfma_f32_16x16x32_bf16 v[200:203], v[68:71], v[152:155], v[200:203]
    v_mfma_f32_16x16x32_bf16 v[208:211], v[72:75], v[152:155], v[208:211]
    v_mfma_f32_16x16x32_bf16 v[216:219], v[76:79], v[152:155], v[216:219]
    v_mfma_f32_16x16x32_bf16 v[204:207], v[68:71], v[156:159], v[204:207]
    v_mfma_f32_16x16x32_bf16 v[212:215], v[72:75], v[156:159], v[212:215]
    v_mfma_f32_16x16x32_bf16 v[220:223], v[76:79], v[156:159], v[220:223]
    v_mfma_f32_16x16x32_bf16 v[192:195], v[96:99], v[128:131], v[192:195]
    v_mfma_f32_16x16x32_bf16 v[196:199], v[96:99], v[132:135], v[196:199]
    s_cmp_eq_u32 s40, 0
    ds_write_b128 v45, v[200:203] offset:2048
    ds_write_b128 v45, v[208:211] offset:4096
    ds_write_b128 v45, v[216:219] offset:6144
    ds_write_b128 v45, v[204:207] offset:3072
    ds_write_b128 v45, v[212:215] offset:5120
    ds_write_b128 v45, v[220:223] offset:7168
    v_mfma_f32_16x16x32_bf16 v[192:195], v[100:103], v[136:139], v[192:195]
    v_mfma_f32_16x16x32_bf16 v[196:199], v[100:103], v[140:143], v[196:199]
    v_mfma_f32_16x16x32_bf16 v[192:195], v[104:107], v[144:147], v[192:195]
    v_mfma_f32_16x16x32_bf16 v[196:199], v[104:107], v[148:151], v[196:199]
    v_mfma_f32_16x16x32_bf16 v[192:195], v[108:111], v[152:155], v[192:195]
    v_mfma_f32_16x16x32_bf16 v[196:199], v[108:111], v[156:159], v[196:199]
    s_cbranch_scc1 L_next
    s_waitcnt lgkmcnt(0)
    s_barrier
L_reduce:
    ds_read_b64 v[46:47], v244
    ds_read_b128 v[72:75], v241
    ds_read_b128 v[76:79], v241 offset:1024
    ds_read_b128 v[80:83], v242
    ds_read_b128 v[84:87], v242 offset:1024
    ds_read_b128 v[88:91], v243
    ds_read_b128 v[92:95], v243 offset:1024
    s_waitcnt lgkmcnt(6)
    v_cmp_eq_u32 vcc, 0, v47
    s_waitcnt lgkmcnt(5)
    v_pk_add_f32 v[192:193], v[192:193], v[72:73]
    v_pk_add_f32 v[194:195], v[194:195], v[74:75]
    s_waitcnt lgkmcnt(4)
    v_pk_add_f32 v[196:197], v[196:197], v[76:77]
    v_pk_add_f32 v[198:199], v[198:199], v[78:79]
    s_waitcnt lgkmcnt(3)
    v_pk_add_f32 v[192:193], v[192:193], v[80:81]
    v_pk_add_f32 v[194:195], v[194:195], v[82:83]
    s_waitcnt lgkmcnt(2)
    v_pk_add_f32 v[196:197], v[196:197], v[84:85]
    v_pk_add_f32 v[198:199], v[198:199], v[86:87]
    s_waitcnt lgkmcnt(1)
    v_pk_add_f32 v[192:193], v[192:193], v[88:89]
    v_pk_add_f32 v[194:195], v[194:195], v[90:91]
    s_waitcnt lgkmcnt(0)
    v_pk_add_f32 v[196:197], v[196:197], v[92:93]
    v_pk_add_f32 v[198:199], v[198:199], v[94:95]
    s_cbranch_vccnz L_pubsafe
    v_bfi_b32 v192, s31, v46, v192
    v_bfi_b32 v194, s31, v46, v194
    global_store_dwordx4 v35, v[192:195], s[58:59]
    v_bfi_b32 v196, s31, v46, v196
    v_bfi_b32 v198, s31, v46, v198
    global_store_dwordx4 v35, v[196:199], s[58:59] offset:1024
    s_endpgm
L_pubsafe:
    v_bfi_b32 v192, s31, v46, v192
    v_bfi_b32 v194, s31, v46, v194
    global_store_dwordx4 v35, v[192:195], s[58:59] sc0 sc1
    v_bfi_b32 v196, s31, v46, v196
    v_bfi_b32 v198, s31, v46, v198
    global_store_dwordx4 v35, v[196:199], s[58:59] offset:1024 sc0 sc1
    s_endpgm
L_respec:
    v_max_u32 v31, v31, v30
    v_add_u32 v245, v24, v31
    v_add_u32 v24, v24, v30
    v_lshlrev_b32 v245, 12, v245
    v_lshl_add_u32 v24, v24, 12, s45
    v_lshl_or_b32 v25, v31, 16, v30
    v_cndmask_b32 v24, 0, v24, vcc
    v_cndmask_b32 v245, 0, v245, vcc
    s_and_b32 s56, s60, vcc_lo
    s_add_u32 s41, s36, 15
    s_lshr_b32 s41, s41, 4
    s_sub_i32 s41, s41, s47
    s_max_i32 s41, s41, 1
    s_cmp_eq_u32 s37, 1
    s_cselect_b32 s56, 0, s56
    s_cmp_lg_u32 s56, 0
    s_cselect_b32 s41, 32, s41
    s_mov_b32 s42, -4
L_next:
    s_add_u32 s42, s42, 4
    s_lshr_b32 s49, s42, 3
    v_cmp_eq_u32 vcc, s49, v34
    s_cmp_eq_u32 s56, 0
    s_nop 3
    s_cselect_b64 vcc, -1, vcc
    v_cndmask_b32 v248, 0, v26, vcc
    v_readlane_b32 s76, v24, s42
    v_readlane_b32 s80, v245, s42
    v_readlane_b32 s28, v25, s42
    s_add_u32 s49, s42, 1
    v_readlane_b32 s77, v24, s49
    v_readlane_b32 s81, v245, s49
    v_readlane_b32 s29, v25, s49
    s_add_u32 s49, s42, 2
    v_readlane_b32 s78, v24, s49
    v_readlane_b32 s82, v245, s49
    v_readlane_b32 s30, v25, s49
    s_add_u32 s49, s42, 3
    v_readlane_b32 s79, v24, s49
    v_readlane_b32 s83, v245, s49
    v_readlane_b32 s69, v25, s49
    s_add_u32 s49, s42, 4
    s_cmp_ge_u32 s49, s41
    s_cselect_b32 s40, 1, 0
    s_waitcnt vmcnt(0) lgkmcnt(0)
    s_nop 4
    s_add_u32 m0, s39, 0
    s_mov_b32 s22, s80
    buffer_load_dwordx4 v4, s[20:23], s76 offen offset:0 nt lds
    buffer_load_dwordx4 v5, s[20:23], s76 offen offset:1024 nt lds
    buffer_load_dwordx4 v6, s[20:23], s76 offen offset:2048 nt lds
    buffer_load_dwordx4 v7, s[20:23], s76 offen offset:3072 nt lds
    s_bitset1_b32 m0, 12
    s_nop 0
    buffer_load_dwordx4 v8, s[20:23], s76 offen offset:0 nt lds
    buffer_load_dwordx4 v9, s[20:23], s76 offen offset:1024 nt lds
    buffer_load_dwordx4 v10, s[20:23], s76 offen offset:2048 nt lds
    buffer_load_dwordx4 v11, s[20:23], s76 offen offset:3072 nt lds
    s_add_u32 m0, s39, 8192
    s_mov_b32 s22, s81
    buffer_load_dwordx4 v4, s[20:23], s77 offen offset:0 nt lds
    buffer_load_dwordx4 v5, s[20:23], s77 offen offset:1024 nt lds
    buffer_load_dwordx4 v6, s[20:23], s77 offen offset:2048 nt lds
    buffer_load_dwordx4 v7, s[20:23], s77 offen offset:3072 nt lds
    s_bitset1_b32 m0, 12
    s_nop 0
    buffer_load_dwordx4 v8, s[20:23], s77 offen offset:0 nt lds
    buffer_load_dwordx4 v9, s[20:23], s77 offen offset:1024 nt lds
    buffer_load_dwordx4 v10, s[20:23], s77 offen offset:2048 nt lds
    buffer_load_dwordx4 v11, s[20:23], s77 offen offset:3072 nt lds
    s_branch L_go
L_rescale:
    v_sub_f32 v32, v27, v30
    v_mul_f32 v32, s46, v32
    v_exp_f32 v32, v32
    s_nop 1
    v_mov_b32_dpp v48, v32 row_newbcast:0 row_mask:0x3 bank_mask:0xf
    v_mov_b32_dpp v48, v32 row_newbcast:8 row_mask:0xc bank_mask:0xf
    v_mov_b32_dpp v50, v32 row_newbcast:1 row_mask:0x3 bank_mask:0xf
    v_mov_b32_dpp v50, v32 row_newbcast:9 row_mask:0xc bank_mask:0xf
    v_mov_b32_dpp v52, v32 row_newbcast:2 row_mask:0x3 bank_mask:0xf
    v_mov_b32_dpp v52, v32 row_newbcast:10 row_mask:0xc bank_mask:0xf
    v_mov_b32_dpp v54, v32 row_newbcast:3 row_mask:0x3 bank_mask:0xf
    v_mov_b32_dpp v54, v32 row_newbcast:11 row_mask:0xc bank_mask:0xf
    v_mul_f32 v28, v28, v32
    v_pk_mul_f32 v[192:193], v[192:193], v[48:49] op_sel_hi:[1,0]
    v_pk_mul_f32 v[194:195], v[194:195], v[48:49] op_sel_hi:[1,0]
    v_pk_mul_f32 v[196:197], v[196:197], v[48:49] op_sel_hi:[1,0]
    v_pk_mul_f32 v[198:199], v[198:199], v[48:49] op_sel_hi:[1,0]
    v_pk_mul_f32 v[200:201], v[200:201], v[50:51] op_sel_hi:[1,0]
    v_pk_mul_f32 v[202:203], v[202:203], v[50:51] op_sel_hi:[1,0]
    v_pk_mul_f32 v[204:205], v[204:205], v[50:51] op_sel_hi:[1,0]
    v_pk_mul_f32 v[206:207], v[206:207], v[50:51] op_sel_hi:[1,0]
    v_pk_mul_f32 v[208:209], v[208:209], v[52:53] op_sel_hi:[1,0]
    v_pk_mul_f32 v[210:211], v[210:211], v[52:53] op_sel_hi:[1,0]
    v_pk_mul_f32 v[212:213], v[212:213], v[52:53] op_sel_hi:[1,0]
    v_pk_mul_f32 v[214:215], v[214:215], v[52:53] op_sel_hi:[1,0]
    v_pk_mul_f32 v[216:217], v[216:217], v[54:55] op_sel_hi:[1,0]
    v_pk_mul_f32 v[218:219], v[218:219], v[54:55] op_sel_hi:[1,0]
    v_pk_mul_f32 v[220:221], v[220:221], v[54:55] op_sel_hi:[1,0]
    v_pk_mul_f32 v[222:223], v[222:223], v[54:55] op_sel_hi:[1,0]
    s_branch L_rescale_ret
L_zeroctx:
    s_waitcnt lgkmcnt(0)
    s_mov_b64 exec, vcc
    v_mov_b32 v26, 4096
    v_mov_b64 v[160:161], 0
    v_mov_b64 v[162:163], 0
    v_mov_b64 v[164:165], 0
    v_mov_b64 v[166:167], 0
    v_mov_b64 v[168:169], 0
    v_mov_b64 v[170:171], 0
    v_mov_b64 v[172:173], 0
    v_mov_b64 v[174:175], 0
    v_mov_b64 v[176:177], 0
    v_mov_b64 v[178:179], 0
    v_mov_b64 v[180:181], 0
    v_mov_b64 v[182:183], 0
    v_mov_b64 v[184:185], 0
    v_mov_b64 v[186:187], 0
    v_mov_b64 v[188:189], 0
    v_mov_b64 v[190:191], 0
    s_mov_b64 exec, -1
    s_nop 0
    s_branch L_zeroctx_ret
.fill 64, 4, 0xbf810000
.section .rodata,"a"
.p2align 6
.amdhsa_kernel standalone__paged_block_table_kv_radixattention__decode_kernel
  .amdhsa_next_free_vgpr 256
  .amdhsa_next_free_sgpr 102
  .amdhsa_accum_offset 256
  .amdhsa_group_segment_fixed_size 0
  .amdhsa_kernarg_size 64
  .amdhsa_user_sgpr_count 2
  .amdhsa_user_sgpr_kernarg_segment_ptr 1
  .amdhsa_system_sgpr_workgroup_id_x 1
.end_amdhsa_kernel
```
